```python
import torch

def _softmax(x, axis=-1):
    return torch.softmax(x, dim=axis)
def _gelu(x):
    return torch.nn.functional.gelu(x, approximate="tanh")
def _silu(x):
    return torch.nn.functional.silu(x)
def _sigmoid(x):
    return torch.sigmoid(x)
def _layernorm(x, axis=-1, eps=1e-5):
    m = x.mean(dim=axis, keepdim=True)
    v = x.var(dim=axis, keepdim=True, unbiased=False)
    return (x - m) / torch.sqrt(v + eps)
def _scatter_add(tgt, idx, src, axis=0):
    return tgt.clone().index_add_(axis, idx, src)
def _segment_sum(src, seg, n):
    out = torch.zeros((n,) + src.shape[1:], dtype=src.dtype)
    return out.index_add_(0, seg, src)
def _pad(x, pw):
    flat = tuple(v for pair in reversed(pw) for v in pair)
    return torch.nn.functional.pad(x, flat)

kernel_name = 'gated_mix__linear_attn_block__ssm_conv_s4__prompt'

def setup_inputs():

    _w = (lambda a: (lambda t: t.to(torch.bfloat16) if t.is_floating_point() else t)(torch.as_tensor(a)))
    def _A_setup():
        B, S, D = 1, 2048, 512
        return {
            "x": _w((lambda *s: torch.randn(*s, dtype=torch.bfloat16) * 0.05)(B, S, D)),
            "wqkv": _w((lambda *s: torch.randn(*s, dtype=torch.bfloat16) * 0.8)(D, 3 * D)),
            "wo": _w((lambda *s: torch.randn(*s, dtype=torch.bfloat16) * 0.05)(D, D)),
        }
    _A_in = _A_setup()

    def _B_setup():
        B, L, D, N = 1, 2048, 512, 128
        A_re = -(lambda _x: torch.exp(torch.as_tensor(_x)))((lambda *s: torch.randn(*s, dtype=torch.bfloat16) * 3.2)(D, N))
        A_im = torch.pi * (lambda *s: torch.randn(*s, dtype=torch.bfloat16) * 0.05)(D, N)
        B_re = (lambda *s: torch.randn(*s, dtype=torch.bfloat16) * 0.2)(D, N)
        B_im = (lambda *s: torch.randn(*s, dtype=torch.bfloat16) * 0.2)(D, N)
        C_re = (lambda *s: torch.randn(*s, dtype=torch.bfloat16) * 0.2)(D, N)
        C_im = (lambda *s: torch.randn(*s, dtype=torch.bfloat16) * 0.2)(D, N)
        log_dt = (lambda *s: torch.randn(*s, dtype=torch.bfloat16) * 0.05)(D) * 0.5 - 4.0
        Dskip = (lambda *s: torch.randn(*s, dtype=torch.bfloat16) * 0.05)(D)
        return {
            "u": _w((lambda *s: torch.randn(*s, dtype=torch.bfloat16) * 0.05)(B, L, D)),
            "A_re": _w(A_re),
            "A_im": _w(A_im),
            "B_re": _w(B_re),
            "B_im": _w(B_im),
            "C_re": _w(C_re),
            "C_im": _w(C_im),
            "log_dt": _w(log_dt),
            "Dskip": _w(Dskip),
        }
    _B_in = _B_setup()

    return {
        "A_x": _A_in["x"],
        "A_wqkv": _A_in["wqkv"],
        "A_wo": _A_in["wo"],
        "B_u": _B_in["u"],
        "B_A_re": _B_in["A_re"],
        "B_A_im": _B_in["A_im"],
        "B_B_re": _B_in["B_re"],
        "B_B_im": _B_in["B_im"],
        "B_C_re": _B_in["C_re"],
        "B_C_im": _B_in["C_im"],
        "B_log_dt": _B_in["log_dt"],
        "B_Dskip": _B_in["Dskip"],
        "gate_w": _w((lambda *s: torch.randn(*s, dtype=torch.bfloat16) * 0.05)(512) * 16.0),
    }

def reference(A_x, A_wqkv, A_wo, B_u, B_A_re, B_A_im, B_B_re, B_B_im, B_C_re, B_C_im, B_log_dt, B_Dskip, gate_w):
    def _A_ref(x, wqkv, wo):
        B, S, D = x.shape
        H = 32; Dh = D // H
        qkv = (lambda x, *d: x.permute(*d))((x @ wqkv).reshape(B, S, 3, H, Dh), 2, 0, 3, 1, 4)
        q, k, v = qkv[0], qkv[1], qkv[2]
        phi = lambda t: torch.where(t > 0, t + 1, torch.exp(t)) + 1e-6
        pq, pk = phi(q), phi(k)
        kv = torch.einsum("bhsd,bhse->bhde", pk, v)
        z = torch.einsum("bhsd->bhd", pk)
        num = torch.einsum("bhqd,bhde->bhqe", pq, kv)
        den = torch.einsum("bhqd,bhd->bhq", pq, z)[..., None] + 1e-6
        o = num / den
        return (lambda x, *d: x.permute(*d))(o, 0, 2, 1, 3).reshape(B, S, D) @ wo

    def _B_ref(u, A_re, A_im, B_re, B_im, C_re, C_im, log_dt, Dskip):
        Bsz, L, D = u.shape
        dt = torch.exp(log_dt)[:, None]
        A = A_re + 1j * A_im
        Bc = B_re + 1j * B_im
        Cc = C_re + 1j * C_im
        logdA = dt * A
        dB = dt * Bc
        l = (lambda x, dt: x.to(dt))(torch.arange(L), A_re.dtype)
        P = torch.exp(logdA[:, :, None] * l[None, None, :])
        K = torch.einsum("dn,dnl,dn->dl", Cc, P, dB).real
        L2 = 2 * L
        Kp = _pad(K, ((0, 0), (0, L)))
        up = (lambda x, *d: x.permute(*d))(u, 0, 2, 1)
        up = _pad(up, ((0, 0), (0, 0), (0, L)))
        Kf = (lambda x, axes=(-2,-1): torch.fft.rfft2(x.float(), dim=axes))(Kp[:, None, :], axes=(-2, -1))
        Uf = (lambda x, axes=(-2,-1): torch.fft.rfft2(x.float(), dim=axes))(up[:, :, None, :], axes=(-2, -1))
        Yf = Uf * Kf[None, :, :, :]
        y = (lambda x, s, axes=(-2,-1): torch.fft.irfft2(x, s=s, dim=axes).to(torch.bfloat16))(Yf, (1, L2), axes=(-2, -1))[:, :, 0, :L]
        y = (lambda x, *d: x.permute(*d))(y, 0, 2, 1) + u * Dskip[None, None, :]
        return y

    x = A_x
    g = _sigmoid((x * gate_w).sum(-1, keepdims=True))
    a = _A_ref(x, A_wqkv, A_wo)
    b = _B_ref(x, B_A_re, B_A_im, B_B_re, B_B_im, B_C_re, B_C_im, B_log_dt, B_Dskip)
    return g * a + (1 - g) * b
```

```asm
; @launch grid=(256,1,1) block=(512,1,1) lds=163840
.amdgcn_target "amdgcn-amd-amdhsa--gfx950"
.text
.globl gated_mix__linear_attn_block__ssm_conv_s4__prompt_kernel
.type gated_mix__linear_attn_block__ssm_conv_s4__prompt_kernel,@function
.p2align 8
gated_mix__linear_attn_block__ssm_conv_s4__prompt_kernel:
    s_cmp_ge_u32 s2, 256
    s_cbranch_scc1 K2_END
    s_load_dwordx16 s[16:31], s[0:1], 0
    s_load_dwordx16 s[32:47], s[0:1], 64
    v_lshrrev_b32 v1, 6, v0
    v_and_b32 v0, 63, v0
    v_readfirstlane_b32 s3, v1
    s_and_b32 s4, s2, 7
    s_lshr_b32 s5, s2, 3
    s_getpc_b64 s[62:63]
K1_PC0:
    s_lshl_b32 s6, s5, 3
    s_add_u32 s6, s6, s3
    s_lshl_b32 s6, s6, 7
    s_min_u32 s6, s6, CODE_END-K1_PC0-4
    v_mov_b32 v1, s6
    global_load_dword v253, v1, s[62:63]
    s_cmp_lt_u32 s5, 16
    s_cbranch_scc1 K1_G
    s_sub_u32 s5, s5, 16
    s_and_b32 s9, s3, 3
    s_lshl_b32 s6, s4, 6
    s_lshl_b32 s7, s5, 2
    s_add_u32 s6, s6, s7
    s_add_u32 s7, s6, s9
    s_lshl_b32 s8, s7, 8
    v_lshlrev_b32 v1, 2, v0
    v_add_u32 v1, s8, v1
    s_lshl_b32 s10, s7, 1
    v_mov_b32 v2, s10
    v_mov_b32 v10, 0
    v_mov_b32 v252, 0
    s_waitcnt lgkmcnt(0)
    global_load_short_d16_hi v10, v2, s[36:37]
    global_load_dword v4, v1, s[24:25]
    global_load_dword v5, v1, s[26:27]
    s_cmp_ge_u32 s3, 4
    s_cbranch_scc1 K1_HELPER
    global_load_dword v6, v1, s[28:29]
    global_load_dword v7, v1, s[30:31]
    global_load_dword v8, v1, s[32:33]
    global_load_dword v9, v1, s[34:35]
    global_load_short_d16_hi v252, v2, s[38:39]
    s_branch K1_SSMC
K1_G:
    s_and_b32 s6, s4, 3
    s_lshl_b32 s6, s6, 2
    s_and_b32 s14, s5, 3
    s_add_u32 s6, s6, s14
    s_lshr_b32 s7, s4, 2
    s_lshl_b32 s7, s7, 2
    s_lshr_b32 s15, s5, 2
    s_add_u32 s7, s7, s15
    s_cmp_ge_u32 s3, 4
    s_cbranch_scc1 K1_LOADER
    s_cmp_ge_u32 s3, 2
    s_cbranch_scc1 K1_GEMM
    s_and_b32 s8, s4, 3
    s_lshl_b32 s8, s8, 9
    s_lshl_b32 s9, s5, 5
    s_add_u32 s8, s8, s9
    v_add_u32 v2, s8, v0
    v_lshlrev_b32 v2, 10, v2
    s_lshl_b32 s8, s3, 7
    v_add_u32 v2, s8, v2
    s_lshl_b32 s8, s3, 6
    s_lshl_b32 s9, s5, 2
    s_add_u32 s8, s8, s9
    v_bfe_u32 v3, v0, 3, 2
    v_add_u32 v3, s8, v3
    v_mul_u32_u24 v3, 3072, v3
    v_bfe_u32 v4, v0, 2, 1
    v_lshl_add_u32 v3, v4, 10, v3
    v_and_b32 v4, 3, v0
    v_lshl_add_u32 v3, v4, 7, v3
    s_lshr_b32 s8, s4, 2
    s_lshl_b32 s8, s8, 9
    s_add_u32 s8, s8, 1024
    v_add_u32 v3, s8, v3
    s_mov_b32 exec_hi, 0
    s_waitcnt lgkmcnt(0)
    global_load_dword v252, v2, s[16:17]
    global_load_dword v251, v3, s[18:19]
    s_mov_b32 exec_hi, -1
    s_branch K1_GEMM
K1_LOADER:
    s_sub_u32 s13, s3, 4
    v_lshrrev_b32 v2, 3, v0
    v_and_b32 v3, 7, v0
    v_lshrrev_b32 v4, 4, v0
    s_and_b32 s10, s13, 1
    s_lshl_b32 s10, s10, 2
    v_or_b32 v5, s10, v4
    v_xor_b32 v5, v5, v3
    s_lshl_b32 s10, s6, 7
    s_lshl_b32 s11, s13, 3
    s_add_u32 s10, s10, s11
    v_add_u32 v10, s10, v2
    v_lshlrev_b32 v10, 10, v10
    v_lshl_add_u32 v10, v5, 4, v10
    v_lshrrev_b32 v1, 3, v0
    v_and_b32 v3, 7, v0
    v_bfe_u32 v11, v0, 4, 1
    v_lshlrev_b32 v11, 2, v11
    v_xor_b32 v3, v11, v3
    s_lshl_b32 s60, s13, 3
    v_add_u32 v11, s60, v1
    v_mul_u32_u24 v11, 3072, v11
    v_lshl_add_u32 v11, v3, 4, v11
    s_lshl_b32 s60, s7, 7
    v_add_u32 v11, s60, v11
    s_lshl_b32 s12, s13, 10
    s_lshl_b32 s88, s13, 11
    s_add_u32 s88, s88, 130048
    s_add_u32 s60, s15, 0
    s_and_b32 s60, s60, 3
    s_lshl_b32 s80, s60, 15
    s_lshl_b32 s60, s60, 12
    s_add_u32 s84, s60, s12
    s_add_u32 s60, s15, 1
    s_and_b32 s60, s60, 3
    s_lshl_b32 s81, s60, 15
    s_lshl_b32 s60, s60, 12
    s_add_u32 s85, s60, s12
    s_add_u32 s60, s15, 2
    s_and_b32 s60, s60, 3
    s_lshl_b32 s82, s60, 15
    s_lshl_b32 s60, s60, 12
    s_add_u32 s86, s60, s12
    s_add_u32 s60, s15, 3
    s_and_b32 s60, s60, 3
    s_lshl_b32 s83, s60, 15
    s_lshl_b32 s60, s60, 12
    s_add_u32 s87, s60, s12
    s_add_u32 s15, s14, s15
    s_and_b32 s15, s15, 0
    s_lshl_b32 s10, s15, 7
    s_mul_i32 s11, s15, 196608
    s_mov_b32 s50, 0x200000
    s_mov_b32 s51, 0x20000
    s_mov_b32 s54, 0x180000
    s_mov_b32 s55, 0x20000
    s_waitcnt lgkmcnt(0)
    s_mov_b64 s[48:49], s[16:17]
    s_mov_b64 s[52:53], s[18:19]
    s_add_u32 m0, s84, 0
    s_add_u32 s63, s10, s80
    buffer_load_dwordx4 v10, s[48:51], s63 offen lds
    s_add_u32 m0, s85, 0
    s_add_u32 s63, s10, s81
    buffer_load_dwordx4 v10, s[48:51], s63 offen lds
    s_add_u32 m0, s88, 0
    s_add_u32 s63, s11, 0
    buffer_load_dwordx4 v11, s[52:55], s63 offen offset:1024 lds
    buffer_load_dwordx4 v11, s[52:55], s63 offen offset:2048 lds
    s_add_u32 m0, s86, 0
    s_add_u32 s63, s10, s82
    buffer_load_dwordx4 v10, s[48:51], s63 offen lds
    s_add_u32 m0, s87, 0
    s_add_u32 s63, s10, s83
    buffer_load_dwordx4 v10, s[48:51], s63 offen lds
    s_xor_b32 s10, s10, 128
    s_add_u32 m0, s84, 16384
    s_add_u32 s63, s10, s80
    buffer_load_dwordx4 v10, s[48:51], s63 offen lds
    s_add_u32 m0, s85, 16384
    s_add_u32 s63, s10, s81
    buffer_load_dwordx4 v10, s[48:51], s63 offen lds
    s_add_u32 m0, s88, 8192
    s_add_u32 s63, s11, 98304
    buffer_load_dwordx4 v11, s[52:55], s63 offen offset:1024 lds
    buffer_load_dwordx4 v11, s[52:55], s63 offen offset:2048 lds
    s_xor_b32 s11, s11, 196608
    s_add_u32 m0, s86, 16384
    s_add_u32 s63, s10, s82
    buffer_load_dwordx4 v10, s[48:51], s63 offen lds
    s_add_u32 m0, s87, 16384
    s_add_u32 s63, s10, s83
    buffer_load_dwordx4 v10, s[48:51], s63 offen lds
    s_add_u32 m0, s88, 16384
    s_add_u32 s63, s11, 0
    buffer_load_dwordx4 v11, s[52:55], s63 offen offset:1024 lds
    buffer_load_dwordx4 v11, s[52:55], s63 offen offset:2048 lds
    s_and_b32 s8, s13, 1
    s_lshr_b32 s9, s13, 1
    v_and_b32 v1, 31, v0
    v_lshrrev_b32 v2, 5, v0
    v_bfe_u32 v3, v0, 1, 3
    v_xor_b32 v3, v3, v2
    s_lshl_b32 s60, s8, 6
    v_add_u32 v1, s60, v1
    v_lshlrev_b32 v1, 7, v1
    v_xor_b32 v4, 0, v3
    v_lshl_add_u32 v4, v4, 4, v1
    v_xor_b32 v5, 2, v3
    v_lshl_add_u32 v5, v5, 4, v1
    v_xor_b32 v6, 4, v3
    v_lshl_add_u32 v6, v6, 4, v1
    v_xor_b32 v7, 6, v3
    v_lshl_add_u32 v7, v7, 4, v1
    v_bfe_u32 v1, v0, 2, 2
    v_lshlrev_b32 v8, 7, v1
    v_bfe_u32 v1, v0, 4, 1
    v_lshlrev_b32 v1, 5, v1
    v_and_b32 v3, 3, v0
    v_lshl_add_u32 v1, v3, 3, v1
    s_lshl_b32 s60, s9, 6
    v_add_u32 v1, s60, v1
    v_bfe_u32 v3, v0, 3, 1
    v_lshlrev_b32 v3, 6, v3
    v_xor_b32 v1, v1, v3
    v_add_u32 v8, v8, v1
    v_add_u32 v8, 131072, v8
    v_lshl_add_u32 v8, v2, 10, v8
    s_lshl_b32 s14, s7, 2
    s_lshl_b32 s60, s9, 1
    s_add_u32 s14, s14, s60
    s_lshl_b32 s60, s6, 2
    s_lshl_b32 s61, s8, 1
    s_add_u32 s60, s60, s61
    s_lshl_b32 s60, s60, 5
    s_add_u32 s60, s60, s14
    s_lshl_b32 s60, s60, 10
    v_lshlrev_b32 v57, 4, v0
    v_add_u32 v57, s60, v57
    s_mov_b32 s4, 2
    s_mov_b32 s5, 32768
    s_movk_i32 s10, 256
    s_movk_i32 s89, 16384
    s_mov_b32 s56, s46
    s_mov_b32 s57, s47
    s_mov_b32 s58, 0x600000
    s_mov_b32 s59, 0x20000
K1_LD_LOOP:
    s_waitcnt vmcnt(8)
    s_barrier
    s_add_u32 m0, s84, s5
    s_add_u32 s63, s10, s80
    buffer_load_dwordx4 v10, s[48:51], s63 offen lds
    s_add_u32 m0, s85, s5
    s_add_u32 s63, s10, s81
    buffer_load_dwordx4 v10, s[48:51], s63 offen lds
    s_add_u32 s62, s89, 8192
    s_add_u32 m0, s88, s62
    s_add_u32 s63, s11, 98304
    buffer_load_dwordx4 v11, s[52:55], s63 offen offset:1024 lds
    buffer_load_dwordx4 v11, s[52:55], s63 offen offset:2048 lds
    s_mul_i32 s11, s4, 196608
    s_xor_b32 s89, s89, 16384
    s_waitcnt vmcnt(8)
    s_barrier
    s_add_u32 m0, s86, s5
    s_add_u32 s63, s10, s82
    buffer_load_dwordx4 v10, s[48:51], s63 offen lds
    s_add_u32 m0, s87, s5
    s_add_u32 s63, s10, s83
    buffer_load_dwordx4 v10, s[48:51], s63 offen lds
    s_add_u32 m0, s88, s89
    s_add_u32 s63, s11, 0
    buffer_load_dwordx4 v11, s[52:55], s63 offen offset:1024 lds
    buffer_load_dwordx4 v11, s[52:55], s63 offen offset:2048 lds
    s_add_u32 s4, s4, 1
    s_add_u32 s5, s5, 16384
    s_add_u32 s10, s10, 128
    s_cmp_lt_u32 s4, 8
    s_cbranch_scc1 K1_LD_LOOP
    s_waitcnt vmcnt(8)
    s_barrier
    s_add_u32 m0, s88, 24576
    s_add_u32 s63, s11, 98304
    buffer_load_dwordx4 v11, s[52:55], s63 offen offset:1024 lds
    buffer_load_dwordx4 v11, s[52:55], s63 offen offset:2048 lds
    s_mul_i32 s10, s15, 196608
    s_waitcnt vmcnt(6)
    s_barrier
    s_add_u32 m0, s12, 131072
    s_add_u32 s63, s10, 0
    buffer_load_dwordx4 v11, s[52:55], s63 offen lds
    s_add_u32 m0, s12, 135168
    s_add_u32 s63, s10, 98304
    buffer_load_dwordx4 v11, s[52:55], s63 offen lds
    s_xor_b32 s10, s10, 196608
    s_waitcnt vmcnt(4)
    s_barrier
    s_add_u32 m0, s12, 139264
    s_add_u32 s63, s10, 0
    buffer_load_dwordx4 v11, s[52:55], s63 offen lds
    s_add_u32 m0, s12, 143360
    s_add_u32 s63, s10, 98304
    buffer_load_dwordx4 v11, s[52:55], s63 offen lds
    s_mov_b32 s10, 393216
    s_waitcnt vmcnt(4)
    s_barrier
    s_add_u32 m0, s12, 147456
    s_add_u32 s63, s10, 0
    buffer_load_dwordx4 v11, s[52:55], s63 offen lds
    s_add_u32 m0, s12, 151552
    s_add_u32 s63, s10, 98304
    buffer_load_dwordx4 v11, s[52:55], s63 offen lds
    s_mov_b32 s10, 0x3fb8aa3b
    s_mov_b32 s11, 0x3fb8aa3b
    s_mov_b32 s12, 0x358637bd
    s_mov_b32 s61, 32768
    s_waitcnt vmcnt(4)
    s_barrier
    ds_read_b128 v[96:99], v4 offset:0
    ds_read_b64_tr_b16 v[104:105], v8 offset:0
    ds_read_b64_tr_b16 v[106:107], v8 offset:512
    ds_read_b128 v[100:103], v4 offset:4096
    ds_read_b128 v[108:111], v5 offset:0
    ds_read_b64_tr_b16 v[116:117], v8 offset:2048
    ds_read_b64_tr_b16 v[118:119], v8 offset:2560
    ds_read_b128 v[112:115], v5 offset:4096
    ds_read_b128 v[120:123], v6 offset:0
    ds_read_b64_tr_b16 v[128:129], v8 offset:4096
    ds_read_b64_tr_b16 v[130:131], v8 offset:4608
    ds_read_b128 v[124:127], v6 offset:4096
    ds_read_b128 v[132:135], v7 offset:0
    ds_read_b64_tr_b16 v[140:141], v8 offset:6144
    ds_read_b64_tr_b16 v[142:143], v8 offset:6656
    s_lshl_b32 s13, s13, 10
    s_add_u32 m0, s13, 155648
    s_mov_b32 s63, 589824
    buffer_load_dwordx4 v11, s[52:55], s63 offen lds
    s_add_u32 m0, s13, 159744
    s_mov_b32 s63, 688128
    buffer_load_dwordx4 v11, s[52:55], s63 offen lds
    ds_read_b128 v[136:139], v7 offset:4096
    s_waitcnt lgkmcnt(8)
    s_waitcnt vmcnt(4)
    s_barrier
    v_mfma_f32_32x32x16_bf16 v[64:79], v[104:107], v[96:99], 0
    ds_read_b128 v[144:147], v4 offset:16384
    ds_read_b64_tr_b16 v[152:153], v8 offset:8192
    v_mfma_f32_32x32x16_bf16 v[80:95], v[104:107], v[100:103], 0
    ds_read_b64_tr_b16 v[154:155], v8 offset:8704
    ds_read_b128 v[148:151], v4 offset:20480
    v_mfma_f32_32x32x16_bf16 v[64:79], v[116:119], v[108:111], v[64:79]
    ds_read_b128 v[156:159], v5 offset:16384
    ds_read_b64_tr_b16 v[164:165], v8 offset:10240
    v_mfma_f32_32x32x16_bf16 v[80:95], v[116:119], v[112:115], v[80:95]
    ds_read_b64_tr_b16 v[166:167], v8 offset:10752
    ds_read_b128 v[160:163], v5 offset:20480
    s_waitcnt lgkmcnt(8)
    v_mfma_f32_32x32x16_bf16 v[64:79], v[128:131], v[120:123], v[64:79]
    ds_read_b128 v[168:171], v6 offset:16384
    ds_read_b64_tr_b16 v[176:177], v8 offset:12288
    v_mfma_f32_32x32x16_bf16 v[80:95], v[128:131], v[124:127], v[80:95]
    ds_read_b64_tr_b16 v[178:179], v8 offset:12800
    ds_read_b128 v[172:175], v6 offset:20480
    v_mfma_f32_32x32x16_bf16 v[64:79], v[140:143], v[132:135], v[64:79]
    ds_read_b128 v[180:183], v7 offset:16384
    ds_read_b64_tr_b16 v[188:189], v8 offset:14336
    v_mfma_f32_32x32x16_bf16 v[80:95], v[140:143], v[136:139], v[80:95]
    ds_read_b64_tr_b16 v[190:191], v8 offset:14848
    ds_read_b128 v[184:187], v7 offset:20480
    s_waitcnt lgkmcnt(8)
    s_waitcnt vmcnt(2)
    s_barrier
    v_mfma_f32_32x32x16_bf16 v[64:79], v[152:155], v[144:147], v[64:79]
    ds_read_b128 v[96:99], v4 offset:32768
    ds_read_b64_tr_b16 v[104:105], v8 offset:16384
    v_mfma_f32_32x32x16_bf16 v[80:95], v[152:155], v[148:151], v[80:95]
    ds_read_b64_tr_b16 v[106:107], v8 offset:16896
    ds_read_b128 v[100:103], v4 offset:36864
    s_add_u32 m0, s13, 131072
    s_mov_b32 s63, 786432
    buffer_load_dwordx4 v11, s[52:55], s63 offen lds
    v_mfma_f32_32x32x16_bf16 v[64:79], v[164:167], v[156:159], v[64:79]
    ds_read_b128 v[108:111], v5 offset:32768
    ds_read_b64_tr_b16 v[116:117], v8 offset:18432
    v_mfma_f32_32x32x16_bf16 v[80:95], v[164:167], v[160:163], v[80:95]
    ds_read_b64_tr_b16 v[118:119], v8 offset:18944
    ds_read_b128 v[112:115], v5 offset:36864
    s_add_u32 m0, s13, 135168
    s_mov_b32 s63, 884736
    buffer_load_dwordx4 v11, s[52:55], s63 offen lds
    s_waitcnt lgkmcnt(8)
    v_mfma_f32_32x32x16_bf16 v[64:79], v[176:179], v[168:171], v[64:79]
    ds_read_b128 v[120:123], v6 offset:32768
    ds_read_b64_tr_b16 v[128:129], v8 offset:20480
    v_mfma_f32_32x32x16_bf16 v[80:95], v[176:179], v[172:175], v[80:95]
    ds_read_b64_tr_b16 v[130:131], v8 offset:20992
    ds_read_b128 v[124:127], v6 offset:36864
    v_mfma_f32_32x32x16_bf16 v[64:79], v[188:191], v[180:183], v[64:79]
    ds_read_b128 v[132:135], v7 offset:32768
    ds_read_b64_tr_b16 v[140:141], v8 offset:22528
    v_mfma_f32_32x32x16_bf16 v[80:95], v[188:191], v[184:187], v[80:95]
    ds_read_b64_tr_b16 v[142:143], v8 offset:23040
    ds_read_b128 v[136:139], v7 offset:36864
    s_waitcnt lgkmcnt(8)
    s_waitcnt vmcnt(2)
    s_barrier
    v_mfma_f32_32x32x16_bf16 v[64:79], v[104:107], v[96:99], v[64:79]
    ds_read_b128 v[144:147], v4 offset:49152
    ds_read_b64_tr_b16 v[152:153], v8 offset:24576
    v_mfma_f32_32x32x16_bf16 v[80:95], v[104:107], v[100:103], v[80:95]
    ds_read_b64_tr_b16 v[154:155], v8 offset:25088
    ds_read_b128 v[148:151], v4 offset:53248
    s_add_u32 m0, s13, 139264
    s_mov_b32 s63, 983040
    buffer_load_dwordx4 v11, s[52:55], s63 offen lds
    v_mfma_f32_32x32x16_bf16 v[64:79], v[116:119], v[108:111], v[64:79]
    ds_read_b128 v[156:159], v5 offset:49152
    ds_read_b64_tr_b16 v[164:165], v8 offset:26624
    v_mfma_f32_32x32x16_bf16 v[80:95], v[116:119], v[112:115], v[80:95]
    ds_read_b64_tr_b16 v[166:167], v8 offset:27136
    ds_read_b128 v[160:163], v5 offset:53248
    s_add_u32 m0, s13, 143360
    s_mov_b32 s63, 1081344
    buffer_load_dwordx4 v11, s[52:55], s63 offen lds
    s_waitcnt lgkmcnt(8)
    v_mfma_f32_32x32x16_bf16 v[64:79], v[128:131], v[120:123], v[64:79]
    ds_read_b128 v[168:171], v6 offset:49152
    ds_read_b64_tr_b16 v[176:177], v8 offset:28672
    v_mfma_f32_32x32x16_bf16 v[80:95], v[128:131], v[124:127], v[80:95]
    ds_read_b64_tr_b16 v[178:179], v8 offset:29184
    ds_read_b128 v[172:175], v6 offset:53248
    v_mfma_f32_32x32x16_bf16 v[64:79], v[140:143], v[132:135], v[64:79]
    ds_read_b128 v[180:183], v7 offset:49152
    ds_read_b64_tr_b16 v[188:189], v8 offset:30720
    v_mfma_f32_32x32x16_bf16 v[80:95], v[140:143], v[136:139], v[80:95]
    ds_read_b64_tr_b16 v[190:191], v8 offset:31232
    ds_read_b128 v[184:187], v7 offset:53248
    s_waitcnt lgkmcnt(8)
    s_waitcnt vmcnt(2)
    s_barrier
    v_add_u32 v4, 65536, v4
    v_add_u32 v5, 65536, v5
    v_mfma_f32_32x32x16_bf16 v[64:79], v[152:155], v[144:147], v[64:79]
    ds_read_b128 v[96:99], v4 offset:0
    ds_read_b64_tr_b16 v[104:105], v8 offset:0
    v_mfma_f32_32x32x16_bf16 v[80:95], v[152:155], v[148:151], v[80:95]
    ds_read_b64_tr_b16 v[106:107], v8 offset:512
    ds_read_b128 v[100:103], v4 offset:4096
    s_add_u32 m0, s13, 147456
    s_mov_b32 s63, 1179648
    buffer_load_dwordx4 v11, s[52:55], s63 offen lds
    v_mfma_f32_32x32x16_bf16 v[64:79], v[164:167], v[156:159], v[64:79]
    ds_read_b128 v[108:111], v5 offset:0
    ds_read_b64_tr_b16 v[116:117], v8 offset:2048
    v_mfma_f32_32x32x16_bf16 v[80:95], v[164:167], v[160:163], v[80:95]
    ds_read_b64_tr_b16 v[118:119], v8 offset:2560
    ds_read_b128 v[112:115], v5 offset:4096
    s_add_u32 m0, s13, 151552
    s_mov_b32 s63, 1277952
    buffer_load_dwordx4 v11, s[52:55], s63 offen lds
    s_waitcnt lgkmcnt(8)
    v_add_u32 v6, 65536, v6
    v_add_u32 v7, 65536, v7
    v_mfma_f32_32x32x16_bf16 v[64:79], v[176:179], v[168:171], v[64:79]
    ds_read_b128 v[120:123], v6 offset:0
    ds_read_b64_tr_b16 v[128:129], v8 offset:4096
    v_mfma_f32_32x32x16_bf16 v[80:95], v[176:179], v[172:175], v[80:95]
    ds_read_b64_tr_b16 v[130:131], v8 offset:4608
    ds_read_b128 v[124:127], v6 offset:4096
    v_mfma_f32_32x32x16_bf16 v[64:79], v[188:191], v[180:183], v[64:79]
    ds_read_b128 v[132:135], v7 offset:0
    ds_read_b64_tr_b16 v[140:141], v8 offset:6144
    v_mfma_f32_32x32x16_bf16 v[80:95], v[188:191], v[184:187], v[80:95]
    ds_read_b64_tr_b16 v[142:143], v8 offset:6656
    ds_read_b128 v[136:139], v7 offset:4096
    s_waitcnt lgkmcnt(8)
    s_waitcnt vmcnt(2)
    s_barrier
    v_mfma_f32_32x32x16_bf16 v[64:79], v[104:107], v[96:99], v[64:79]
    ds_read_b128 v[144:147], v4 offset:16384
    ds_read_b64_tr_b16 v[152:153], v8 offset:8192
    v_mfma_f32_32x32x16_bf16 v[80:95], v[104:107], v[100:103], v[80:95]
    ds_read_b64_tr_b16 v[154:155], v8 offset:8704
    ds_read_b128 v[148:151], v4 offset:20480
    s_add_u32 m0, s13, 155648
    s_mov_b32 s63, 1376256
    buffer_load_dwordx4 v11, s[52:55], s63 offen lds
    v_mfma_f32_32x32x16_bf16 v[64:79], v[116:119], v[108:111], v[64:79]
    ds_read_b128 v[156:159], v5 offset:16384
    ds_read_b64_tr_b16 v[164:165], v8 offset:10240
    v_mfma_f32_32x32x16_bf16 v[80:95], v[116:119], v[112:115], v[80:95]
    ds_read_b64_tr_b16 v[166:167], v8 offset:10752
    ds_read_b128 v[160:163], v5 offset:20480
    s_add_u32 m0, s13, 159744
    s_mov_b32 s63, 1474560
    buffer_load_dwordx4 v11, s[52:55], s63 offen lds
    s_waitcnt lgkmcnt(8)
    v_mfma_f32_32x32x16_bf16 v[64:79], v[128:131], v[120:123], v[64:79]
    ds_read_b128 v[168:171], v6 offset:16384
    ds_read_b64_tr_b16 v[176:177], v8 offset:12288
    v_mfma_f32_32x32x16_bf16 v[80:95], v[128:131], v[124:127], v[80:95]
    ds_read_b64_tr_b16 v[178:179], v8 offset:12800
    ds_read_b128 v[172:175], v6 offset:20480
    v_mfma_f32_32x32x16_bf16 v[64:79], v[140:143], v[132:135], v[64:79]
    ds_read_b128 v[180:183], v7 offset:16384
    ds_read_b64_tr_b16 v[188:189], v8 offset:14336
    v_mfma_f32_32x32x16_bf16 v[80:95], v[140:143], v[136:139], v[80:95]
    ds_read_b64_tr_b16 v[190:191], v8 offset:14848
    ds_read_b128 v[184:187], v7 offset:20480
    s_waitcnt lgkmcnt(8)
    s_waitcnt vmcnt(2)
    s_barrier
    v_mfma_f32_32x32x16_bf16 v[64:79], v[152:155], v[144:147], v[64:79]
    ds_read_b128 v[96:99], v4 offset:32768
    ds_read_b64_tr_b16 v[104:105], v8 offset:16384
    v_mfma_f32_32x32x16_bf16 v[80:95], v[152:155], v[148:151], v[80:95]
    ds_read_b64_tr_b16 v[106:107], v8 offset:16896
    ds_read_b128 v[100:103], v4 offset:36864
    v_mfma_f32_32x32x16_bf16 v[64:79], v[164:167], v[156:159], v[64:79]
    ds_read_b128 v[108:111], v5 offset:32768
    ds_read_b64_tr_b16 v[116:117], v8 offset:18432
    v_mfma_f32_32x32x16_bf16 v[80:95], v[164:167], v[160:163], v[80:95]
    ds_read_b64_tr_b16 v[118:119], v8 offset:18944
    ds_read_b128 v[112:115], v5 offset:36864
    s_waitcnt lgkmcnt(8)
    v_mfma_f32_32x32x16_bf16 v[64:79], v[176:179], v[168:171], v[64:79]
    ds_read_b128 v[120:123], v6 offset:32768
    ds_read_b64_tr_b16 v[128:129], v8 offset:20480
    v_mfma_f32_32x32x16_bf16 v[80:95], v[176:179], v[172:175], v[80:95]
    ds_read_b64_tr_b16 v[130:131], v8 offset:20992
    ds_read_b128 v[124:127], v6 offset:36864
    v_mfma_f32_32x32x16_bf16 v[64:79], v[188:191], v[180:183], v[64:79]
    ds_read_b128 v[132:135], v7 offset:32768
    ds_read_b64_tr_b16 v[140:141], v8 offset:22528
    v_mfma_f32_32x32x16_bf16 v[80:95], v[188:191], v[184:187], v[80:95]
    ds_read_b64_tr_b16 v[142:143], v8 offset:23040
    ds_read_b128 v[136:139], v7 offset:36864
    s_waitcnt lgkmcnt(8)
    s_waitcnt vmcnt(0)
    s_barrier
    v_mfma_f32_32x32x16_bf16 v[64:79], v[104:107], v[96:99], v[64:79]
    ds_read_b128 v[144:147], v4 offset:49152
    ds_read_b64_tr_b16 v[152:153], v8 offset:24576
    v_mfma_f32_32x32x16_bf16 v[80:95], v[104:107], v[100:103], v[80:95]
    ds_read_b64_tr_b16 v[154:155], v8 offset:25088
    ds_read_b128 v[148:151], v4 offset:53248
    v_mfma_f32_32x32x16_bf16 v[64:79], v[116:119], v[108:111], v[64:79]
    ds_read_b128 v[156:159], v5 offset:49152
    ds_read_b64_tr_b16 v[164:165], v8 offset:26624
    v_mfma_f32_32x32x16_bf16 v[80:95], v[116:119], v[112:115], v[80:95]
    ds_read_b64_tr_b16 v[166:167], v8 offset:27136
    ds_read_b128 v[160:163], v5 offset:53248
    s_waitcnt lgkmcnt(8)
    v_mfma_f32_32x32x16_bf16 v[64:79], v[128:131], v[120:123], v[64:79]
    ds_read_b128 v[168:171], v6 offset:49152
    ds_read_b64_tr_b16 v[176:177], v8 offset:28672
    ds_read_b64_tr_b16 v[178:179], v8 offset:29184
    ds_read_b128 v[172:175], v6 offset:53248
    v_mfma_f32_32x32x16_bf16 v[64:79], v[140:143], v[132:135], v[64:79]
    ds_read_b128 v[180:183], v7 offset:49152
    ds_read_b64_tr_b16 v[188:189], v8 offset:30720
    ds_read_b64_tr_b16 v[190:191], v8 offset:31232
    ds_read_b128 v[184:187], v7 offset:53248
    s_waitcnt lgkmcnt(8)
    v_mfma_f32_32x32x16_bf16 v[64:79], v[152:155], v[144:147], v[64:79]
    v_mfma_f32_32x32x16_bf16 v[64:79], v[164:167], v[156:159], v[64:79]
    s_waitcnt lgkmcnt(0)
    v_mfma_f32_32x32x16_bf16 v[64:79], v[176:179], v[168:171], v[64:79]
    v_mfma_f32_32x32x16_bf16 v[64:79], v[188:191], v[180:183], v[64:79]
    v_mfma_f32_32x32x16_bf16 v[80:95], v[128:131], v[124:127], v[80:95]
    v_mfma_f32_32x32x16_bf16 v[80:95], v[140:143], v[136:139], v[80:95]
    v_mfma_f32_32x32x16_bf16 v[80:95], v[152:155], v[148:151], v[80:95]
    s_nop 8
    v_mul_f32 v208, s10, v64
    v_mul_f32 v209, s10, v65
    v_mul_f32 v210, s10, v66
    v_mul_f32 v211, s10, v67
    v_mul_f32 v212, s10, v68
    v_mul_f32 v213, s10, v69
    v_mul_f32 v214, s10, v70
    v_mfma_f32_32x32x16_bf16 v[80:95], v[164:167], v[160:163], v[80:95]
    v_mul_f32 v215, s10, v71
    v_exp_f32_e64 v208, v208 clamp
    v_max_f32 v64, s12, v64
    v_exp_f32_e64 v209, v209 clamp
    v_max_f32 v65, s12, v65
    v_mfma_f32_32x32x16_bf16 v[80:95], v[176:179], v[172:175], v[80:95]
    v_exp_f32_e64 v210, v210 clamp
    v_max_f32 v66, s12, v66
    v_exp_f32_e64 v211, v211 clamp
    v_max_f32 v67, s12, v67
    v_exp_f32_e64 v212, v212 clamp
    v_mfma_f32_32x32x16_bf16 v[80:95], v[188:191], v[184:187], v[80:95]
    v_max_f32 v68, s12, v68
    v_exp_f32_e64 v213, v213 clamp
    v_max_f32 v69, s12, v69
    v_exp_f32_e64 v214, v214 clamp
    v_max_f32 v70, s12, v70
    v_exp_f32_e64 v215, v215 clamp
    v_max_f32 v71, s12, v71
    v_add_f32 v64, v64, v208
    v_add_f32 v65, v65, v209
    v_add_f32 v66, v66, v210
    v_add_f32 v67, v67, v211
    v_add_f32 v68, v68, v212
    v_add_f32 v69, v69, v213
    v_add_f32 v70, v70, v214
    v_add_f32 v71, v71, v215
    v_cvt_pk_bf16_f32 v16, v64, v65
    v_cvt_pk_bf16_f32 v17, v66, v67
    v_cvt_pk_bf16_f32 v18, v68, v69
    v_cvt_pk_bf16_f32 v19, v70, v71
    buffer_store_dwordx4 v[16:19], v57, s[56:59], 0 offen sc1
    v_pk_mul_f32 v[216:217], v[72:73], s[10:11]
    v_pk_mul_f32 v[218:219], v[74:75], s[10:11]
    v_pk_mul_f32 v[220:221], v[76:77], s[10:11]
    v_pk_mul_f32 v[222:223], v[78:79], s[10:11]
    v_exp_f32_e64 v216, v216 clamp
    v_max_f32 v72, s12, v72
    v_exp_f32_e64 v217, v217 clamp
    v_max_f32 v73, s12, v73
    v_exp_f32_e64 v218, v218 clamp
    v_max_f32 v74, s12, v74
    v_exp_f32_e64 v219, v219 clamp
    v_max_f32 v75, s12, v75
    v_exp_f32_e64 v220, v220 clamp
    v_max_f32 v76, s12, v76
    v_exp_f32_e64 v221, v221 clamp
    v_max_f32 v77, s12, v77
    v_exp_f32_e64 v222, v222 clamp
    v_max_f32 v78, s12, v78
    v_exp_f32_e64 v223, v223 clamp
    v_max_f32 v79, s12, v79
    v_pk_add_f32 v[72:73], v[72:73], v[216:217]
    v_pk_add_f32 v[74:75], v[74:75], v[218:219]
    v_pk_add_f32 v[76:77], v[76:77], v[220:221]
    v_pk_add_f32 v[78:79], v[78:79], v[222:223]
    v_cvt_pk_bf16_f32 v20, v72, v73
    v_cvt_pk_bf16_f32 v21, v74, v75
    v_cvt_pk_bf16_f32 v22, v76, v77
    v_cvt_pk_bf16_f32 v23, v78, v79
    buffer_store_dwordx4 v[20:23], v57, s[56:59], 0 offen offset:1024 sc1
    v_pk_mul_f32 v[208:209], v[80:81], s[10:11]
    v_pk_mul_f32 v[210:211], v[82:83], s[10:11]
    v_pk_mul_f32 v[212:213], v[84:85], s[10:11]
    v_pk_mul_f32 v[214:215], v[86:87], s[10:11]
    v_exp_f32_e64 v208, v208 clamp
    v_max_f32 v80, s12, v80
    v_exp_f32_e64 v209, v209 clamp
    v_max_f32 v81, s12, v81
    v_exp_f32_e64 v210, v210 clamp
    v_max_f32 v82, s12, v82
    v_exp_f32_e64 v211, v211 clamp
    v_max_f32 v83, s12, v83
    v_exp_f32_e64 v212, v212 clamp
    v_max_f32 v84, s12, v84
    v_exp_f32_e64 v213, v213 clamp
    v_max_f32 v85, s12, v85
    v_exp_f32_e64 v214, v214 clamp
    v_max_f32 v86, s12, v86
    v_exp_f32_e64 v215, v215 clamp
    v_max_f32 v87, s12, v87
    v_pk_add_f32 v[80:81], v[80:81], v[208:209]
    v_pk_add_f32 v[82:83], v[82:83], v[210:211]
    v_pk_add_f32 v[84:85], v[84:85], v[212:213]
    v_pk_add_f32 v[86:87], v[86:87], v[214:215]
    v_cvt_pk_bf16_f32 v24, v80, v81
    v_cvt_pk_bf16_f32 v25, v82, v83
    v_cvt_pk_bf16_f32 v26, v84, v85
    v_cvt_pk_bf16_f32 v27, v86, v87
    buffer_store_dwordx4 v[24:27], v57, s[56:59], s61 offen offset:0 sc1
    v_pk_mul_f32 v[216:217], v[88:89], s[10:11]
    v_pk_mul_f32 v[218:219], v[90:91], s[10:11]
    v_pk_mul_f32 v[220:221], v[92:93], s[10:11]
    v_pk_mul_f32 v[222:223], v[94:95], s[10:11]
    v_exp_f32_e64 v216, v216 clamp
    v_max_f32 v88, s12, v88
    v_exp_f32_e64 v217, v217 clamp
    v_max_f32 v89, s12, v89
    v_exp_f32_e64 v218, v218 clamp
    v_max_f32 v90, s12, v90
    v_exp_f32_e64 v219, v219 clamp
    v_max_f32 v91, s12, v91
    v_exp_f32_e64 v220, v220 clamp
    v_max_f32 v92, s12, v92
    v_exp_f32_e64 v221, v221 clamp
    v_max_f32 v93, s12, v93
    v_exp_f32_e64 v222, v222 clamp
    v_max_f32 v94, s12, v94
    v_exp_f32_e64 v223, v223 clamp
    v_max_f32 v95, s12, v95
    v_pk_add_f32 v[88:89], v[88:89], v[216:217]
    v_pk_add_f32 v[90:91], v[90:91], v[218:219]
    v_pk_add_f32 v[92:93], v[92:93], v[220:221]
    v_pk_add_f32 v[94:95], v[94:95], v[222:223]
    v_cvt_pk_bf16_f32 v28, v88, v89
    v_cvt_pk_bf16_f32 v29, v90, v91
    v_cvt_pk_bf16_f32 v30, v92, v93
    v_cvt_pk_bf16_f32 v31, v94, v95
    buffer_store_dwordx4 v[28:31], v57, s[56:59], s61 offen offset:1024 sc1
    s_mov_b32 s92, s7
    s_branch K_SYNC
K1_HELPER:
    s_setprio 2
    s_and_b32 s6, s4, 3
    s_lshr_b32 s7, s4, 2
    s_lshl_b32 s10, s6, 9
    s_lshl_b32 s11, s5, 4
    s_add_u32 s10, s10, s11
    s_lshl_b32 s11, s7, 8
    s_add_u32 s14, s10, s11
    s_lshl_b32 s15, s9, 2
    s_add_u32 s14, s14, s15
    s_xor_b32 s11, s11, 256
    s_add_u32 s10, s10, s11
    v_add_u32 v6, s10, v0
    v_lshlrev_b32 v6, 10, v6
    v_subrev_u32 v7, 16, v0
    v_mul_u32_u24 v8, 43, v7
    v_bfe_u32 v8, v8, 9, 3
    v_mul_u32_u24 v9, 12, v8
    v_sub_u32 v9, v7, v9
    s_lshl_b32 s10, s5, 2
    v_add_u32 v8, s10, v8
    v_mul_u32_u24 v8, 3072, v8
    v_bfe_u32 v11, v9, 2, 2
    v_lshl_add_u32 v8, v11, 10, v8
    v_and_b32 v11, 3, v9
    v_lshl_add_u32 v8, v11, 7, v8
    s_lshl_b32 s10, s7, 9
    v_add_u32 v8, s10, v8
    s_mov_b64 s[10:11], 0xffff
    v_cndmask_b32_e64 v6, v8, v6, s[10:11]
    v_mov_b32 v7, 196608
    v_mov_b32 v8, 128
    v_cndmask_b32_e64 v7, v7, v8, s[10:11]
    v_mov_b32 v8, s18
    v_mov_b32 v9, s16
    v_cndmask_b32_e64 v8, v8, v9, s[10:11]
    v_mov_b32 v9, s19
    v_mov_b32 v11, s17
    v_cndmask_b32_e64 v9, v9, v11, s[10:11]
    s_lshr_b32 s60, s9, 1
    s_add_u32 s60, s60, 2
    v_mad_u32_u24 v14, v7, s60, v6
    v_add_co_u32 v14, vcc, v8, v14
    s_nop 1
    v_addc_co_u32 v15, vcc, 0, v9, vcc
    s_bitcmp1_b32 s9, 0
    s_cselect_b32 exec_lo, 0, -1
    s_cselect_b32 exec_hi, -1, 0
    global_load_dword v44, v[14:15], off
    s_mov_b64 s[90:91], exec
    s_mov_b64 exec, -1
    s_add_u32 s60, s9, 4
    v_mad_u32_u24 v14, v7, s60, v6
    v_add_co_u32 v14, vcc, v8, v14
    s_nop 1
    v_addc_co_u32 v15, vcc, 0, v9, vcc
    s_lshr_b32 s60, s9, 1
    s_lshl_b32 s60, s60, 6
    s_and_b32 s61, s9, 1
    s_lshl_b32 s61, s61, 1
    s_add_u32 s60, s60, s61
    s_lshl_b32 s61, s5, 2
    s_add_u32 s60, s60, s61
    v_bfe_u32 v104, v0, 2, 1
    v_add_u32 v104, s60, v104
    v_mul_u32_u24 v104, 3072, v104
    v_and_b32 v105, 3, v0
    v_lshl_add_u32 v104, v105, 7, v104
    s_lshl_b32 s60, s7, 9
    s_add_u32 s60, s60, s18
    s_addc_u32 s61, s19, 0
    v_mov_b32 v105, s61
    v_add_co_u32 v104, vcc, s60, v104
    s_nop 1
    v_addc_co_u32 v105, vcc, 0, v105, vcc
    s_lshl_b32 s15, s14, 10
    v_lshlrev_b32 v12, 4, v0
    v_add_u32 v13, s15, v12
    s_lshl_b32 s15, s9, 6
    v_add_u32 v1, s15, v0
    s_lshl_b32 s15, s4, 7
    s_lshl_b32 s60, s5, 3
    s_add_u32 s15, s15, s60
    v_lshlrev_b32 v2, 10, v1
    v_add_u32 v2, s15, v2
    s_lshl_b32 s60, s5, 7
    s_lshl_b32 s61, s9, 5
    s_add_u32 s60, s60, s61
    v_and_b32 v11, 31, v0
    v_add_u32 v11, s60, v11
    v_lshlrev_b32 v11, 10, v11
    v_add_u32 v11, s15, v11
    s_mul_i32 s8, s9, 38144
    v_lshlrev_b32 v3, 3, v0
    v_add_u32 v3, s8, v3
    v_add_u32 v3, 11616, v3
    s_mov_b32 s48, s16
    s_mov_b32 s49, s17
    s_mov_b32 s50, 0x200000
    s_mov_b32 s51, 0x20000
    s_waitcnt vmcnt(3)
    v_mul_f32 v10, 0x3fb8aa3b, v10
    v_exp_f32 v10, v10
    s_nop 0
    v_cvt_pk_bf16_f32 v10, v10, v10
    v_and_b32 v10, 0xffff0000, v10
    s_waitcnt vmcnt(1)
    v_lshlrev_b32 v20, 16, v4
    v_and_b32 v21, 0xffff0000, v4
    v_lshlrev_b32 v22, 16, v5
    v_and_b32 v23, 0xffff0000, v5
    v_mul_f32 v20, v10, v20
    v_mul_f32 v21, v10, v21
    v_mul_f32 v22, v10, v22
    v_mul_f32 v23, v10, v23
    v_mul_f32 v24, 0x4138aa3b, v20
    v_mul_f32 v26, 0xbfa2f983, v22
    v_mul_f32 v25, 0x4138aa3b, v21
    v_mul_f32 v27, 0xbfa2f983, v23
    v_mul_f32 v28, 0x41b8aa3b, v20
    v_mul_f32 v30, 0xc022f983, v22
    v_mul_f32 v29, 0x41b8aa3b, v21
    v_mul_f32 v31, 0xc022f983, v23
    v_exp_f32 v24, v24
    v_fract_f32 v26, v26
    v_exp_f32 v25, v25
    v_fract_f32 v27, v27
    v_exp_f32 v28, v28
    v_fract_f32 v30, v30
    v_exp_f32 v29, v29
    v_fract_f32 v31, v31
    v_cos_f32 v72, v26
    v_sin_f32 v73, v26
    v_cos_f32 v74, v27
    v_sin_f32 v75, v27
    v_cos_f32 v76, v30
    v_sin_f32 v77, v30
    v_cos_f32 v78, v31
    v_sin_f32 v79, v31
    v_mul_f32 v72, v24, v72
    v_mul_f32 v73, v24, v73
    v_mul_f32 v74, v25, v74
    v_mul_f32 v75, v25, v75
    v_mul_f32 v76, v28, v76
    v_mul_f32 v77, v28, v77
    v_mul_f32 v78, v29, v78
    v_mul_f32 v79, v29, v79
    s_mov_b32 s56, s46
    s_mov_b32 s57, s47
    s_mov_b32 s58, 0x600000
    s_mov_b32 s59, 0x20000
    v_mov_b32 v40, 0
    v_mov_b32 v41, 0
    v_mov_b32 v42, 0
    v_mov_b32 v43, 0
    s_lshl_b32 s61, s5, 2
    s_add_u32 s61, s61, s9
    s_cmp_lg_u32 s61, 3
    s_cbranch_scc1 K1_H_NOZ
    s_mul_i32 s13, s4, 8192
    s_add_u32 s13, s13, 0x400000
    buffer_store_dwordx4 v[40:43], v12, s[56:59], s13 offen offset:0 sc0 sc1
    buffer_store_dwordx4 v[40:43], v12, s[56:59], s13 offen offset:1024 sc0 sc1
    buffer_store_dwordx4 v[40:43], v12, s[56:59], s13 offen offset:2048 sc0 sc1
    buffer_store_dwordx4 v[40:43], v12, s[56:59], s13 offen offset:3072 sc0 sc1
    s_add_u32 s13, s13, 4096
    buffer_store_dwordx4 v[40:43], v12, s[56:59], s13 offen offset:0 sc0 sc1
    buffer_store_dwordx4 v[40:43], v12, s[56:59], s13 offen offset:1024 sc0 sc1
    buffer_store_dwordx4 v[40:43], v12, s[56:59], s13 offen offset:2048 sc0 sc1
    buffer_store_dwordx4 v[40:43], v12, s[56:59], s13 offen offset:3072 sc0 sc1
    s_lshl_b32 s13, s4, 14
    s_add_u32 s13, s13, 0x420000
    v_lshlrev_b32 v39, 8, v0
    buffer_store_dword v40, v39, s[56:59], s13 offen sc0 sc1
K1_H_NOZ:
    buffer_load_dwordx4 v[48:51], v13, s[48:51], 0 offen offset:0
    buffer_load_dwordx4 v[52:55], v13, s[48:51], 0 offen offset:1024
    buffer_load_dwordx4 v[56:59], v13, s[48:51], 0 offen offset:2048
    buffer_load_dwordx4 v[60:63], v13, s[48:51], 0 offen offset:3072
    global_load_dwordx4 v[64:67], v12, s[40:41]
    v_mov_b32 v80, 1.0
    v_mov_b32 v81, 0
    v_mov_b32 v82, 1.0
    v_mov_b32 v83, 0
    v_mov_b64 v[88:89], v[72:73]
    v_mov_b64 v[90:91], v[74:75]
    s_mov_b32 s60, 8
K1_H_BL:
    v_pk_mul_f32 v[84:85], v[80:81], v[76:77] op_sel:[0,0] op_sel_hi:[1,0]
    v_pk_mul_f32 v[86:87], v[82:83], v[78:79] op_sel:[0,0] op_sel_hi:[1,0]
    v_pk_mul_f32 v[92:93], v[88:89], v[76:77] op_sel:[0,0] op_sel_hi:[1,0]
    v_pk_mul_f32 v[94:95], v[90:91], v[78:79] op_sel:[0,0] op_sel_hi:[1,0]
    v_cvt_pk_bf16_f32 v96, v80, v81
    v_cvt_pk_bf16_f32 v97, v82, v83
    v_pk_fma_f32 v[84:85], v[80:81], v[76:77], v[84:85] op_sel:[1,1,0] op_sel_hi:[0,1,1] neg_lo:[1,0,0]
    v_pk_fma_f32 v[86:87], v[82:83], v[78:79], v[86:87] op_sel:[1,1,0] op_sel_hi:[0,1,1] neg_lo:[1,0,0]
    v_cvt_pk_bf16_f32 v98, v88, v89
    v_cvt_pk_bf16_f32 v99, v90, v91
    v_pk_fma_f32 v[92:93], v[88:89], v[76:77], v[92:93] op_sel:[1,1,0] op_sel_hi:[0,1,1] neg_lo:[1,0,0]
    v_pk_fma_f32 v[94:95], v[90:91], v[78:79], v[94:95] op_sel:[1,1,0] op_sel_hi:[0,1,1] neg_lo:[1,0,0]
    ds_write2_b64 v3, v[96:97], v[98:99] offset0:0 offset1:66
    v_pk_mul_f32 v[80:81], v[84:85], v[76:77] op_sel:[0,0] op_sel_hi:[1,0]
    v_pk_mul_f32 v[82:83], v[86:87], v[78:79] op_sel:[0,0] op_sel_hi:[1,0]
    v_pk_mul_f32 v[88:89], v[92:93], v[76:77] op_sel:[0,0] op_sel_hi:[1,0]
    v_pk_mul_f32 v[90:91], v[94:95], v[78:79] op_sel:[0,0] op_sel_hi:[1,0]
    v_cvt_pk_bf16_f32 v100, v84, v85
    v_cvt_pk_bf16_f32 v101, v86, v87
    v_pk_fma_f32 v[80:81], v[84:85], v[76:77], v[80:81] op_sel:[1,1,0] op_sel_hi:[0,1,1] neg_lo:[1,0,0]
    v_pk_fma_f32 v[82:83], v[86:87], v[78:79], v[82:83] op_sel:[1,1,0] op_sel_hi:[0,1,1] neg_lo:[1,0,0]
    v_cvt_pk_bf16_f32 v102, v92, v93
    v_cvt_pk_bf16_f32 v103, v94, v95
    v_pk_fma_f32 v[88:89], v[92:93], v[76:77], v[88:89] op_sel:[1,1,0] op_sel_hi:[0,1,1] neg_lo:[1,0,0]
    v_pk_fma_f32 v[90:91], v[94:95], v[78:79], v[90:91] op_sel:[1,1,0] op_sel_hi:[0,1,1] neg_lo:[1,0,0]
    ds_write2_b64 v3, v[100:101], v[102:103] offset0:132 offset1:198
    v_add_u32 v3, 2112, v3
    s_cmp_lg_u32 s60, 5
    s_cbranch_scc1 K1_H_NU
    global_load_dword v46, v[14:15], off
K1_H_NU:
    s_cmp_lg_u32 s60, 3
    s_cbranch_scc1 K1_H_NU2
    buffer_load_dword v45, v11, s[48:51], 0 offen
K1_H_NU2:
    s_sub_u32 s60, s60, 1
    s_cmp_lg_u32 s60, 0
    s_cbranch_scc1 K1_H_BL
    s_waitcnt lgkmcnt(0)
    s_barrier
    global_load_dword v47, v[104:105], off
    s_setprio 0
    s_waitcnt vmcnt(3)
    s_cmp_lg_u32 s61, 3
    s_cbranch_scc1 K1_H_NOF
    s_lshl_b32 s13, s4, 2
    v_mov_b32 v6, s13
    v_mov_b32 v7, 1
    s_mov_b64 exec, 1
    global_store_dword v6, v7, s[44:45] sc0 sc1
    s_mov_b64 exec, -1
K1_H_NOF:
    s_mov_b32 s13, 0
    buffer_load_dwordx2 v[16:17], v2, s[48:51], s13 offen
    v_mov_b32 v68, 0
    v_mov_b32 v69, 0
    v_mov_b32 v70, 0
    v_mov_b32 v71, 0
    v_dot2c_f32_bf16 v68, v48, v64
    v_dot2c_f32_bf16 v69, v52, v64
    v_dot2c_f32_bf16 v70, v56, v64
    v_dot2c_f32_bf16 v71, v60, v64
    v_dot2c_f32_bf16 v68, v49, v65
    v_dot2c_f32_bf16 v69, v53, v65
    v_dot2c_f32_bf16 v70, v57, v65
    v_dot2c_f32_bf16 v71, v61, v65
    v_dot2c_f32_bf16 v68, v50, v66
    v_dot2c_f32_bf16 v69, v54, v66
    v_dot2c_f32_bf16 v70, v58, v66
    v_dot2c_f32_bf16 v71, v62, v66
    v_dot2c_f32_bf16 v68, v51, v67
    v_dot2c_f32_bf16 v69, v55, v67
    v_dot2c_f32_bf16 v70, v59, v67
    v_dot2c_f32_bf16 v71, v63, v67
    s_mov_b32 s13, 262144
    buffer_load_dwordx2 v[18:19], v2, s[48:51], s13 offen
    v_add_f32_dpp v68, v68, v68 row_shr:1 row_mask:0xf bank_mask:0xf bound_ctrl:0
    v_add_f32_dpp v69, v69, v69 row_shr:1 row_mask:0xf bank_mask:0xf bound_ctrl:0
    v_add_f32_dpp v70, v70, v70 row_shr:1 row_mask:0xf bank_mask:0xf bound_ctrl:0
    v_add_f32_dpp v71, v71, v71 row_shr:1 row_mask:0xf bank_mask:0xf bound_ctrl:0
    v_add_f32_dpp v68, v68, v68 row_shr:2 row_mask:0xf bank_mask:0xf bound_ctrl:0
    v_add_f32_dpp v69, v69, v69 row_shr:2 row_mask:0xf bank_mask:0xf bound_ctrl:0
    v_add_f32_dpp v70, v70, v70 row_shr:2 row_mask:0xf bank_mask:0xf bound_ctrl:0
    v_add_f32_dpp v71, v71, v71 row_shr:2 row_mask:0xf bank_mask:0xf bound_ctrl:0
    v_add_f32_dpp v68, v68, v68 row_shr:4 row_mask:0xf bank_mask:0xf bound_ctrl:0
    v_add_f32_dpp v69, v69, v69 row_shr:4 row_mask:0xf bank_mask:0xf bound_ctrl:0
    v_add_f32_dpp v70, v70, v70 row_shr:4 row_mask:0xf bank_mask:0xf bound_ctrl:0
    v_add_f32_dpp v71, v71, v71 row_shr:4 row_mask:0xf bank_mask:0xf bound_ctrl:0
    v_add_f32_dpp v68, v68, v68 row_shr:8 row_mask:0xf bank_mask:0xf bound_ctrl:0
    v_add_f32_dpp v69, v69, v69 row_shr:8 row_mask:0xf bank_mask:0xf bound_ctrl:0
    v_add_f32_dpp v70, v70, v70 row_shr:8 row_mask:0xf bank_mask:0xf bound_ctrl:0
    v_add_f32_dpp v71, v71, v71 row_shr:8 row_mask:0xf bank_mask:0xf bound_ctrl:0
    s_mov_b32 s13, 524288
    buffer_load_dwordx2 v[20:21], v2, s[48:51], s13 offen
    v_add_f32_dpp v68, v68, v68 row_bcast:15 row_mask:0xa bank_mask:0xf
    v_add_f32_dpp v69, v69, v69 row_bcast:15 row_mask:0xa bank_mask:0xf
    v_add_f32_dpp v70, v70, v70 row_bcast:15 row_mask:0xa bank_mask:0xf
    v_add_f32_dpp v71, v71, v71 row_bcast:15 row_mask:0xa bank_mask:0xf
    v_add_f32_dpp v68, v68, v68 row_bcast:31 row_mask:0xc bank_mask:0xf
    v_add_f32_dpp v69, v69, v69 row_bcast:31 row_mask:0xc bank_mask:0xf
    v_add_f32_dpp v70, v70, v70 row_bcast:31 row_mask:0xc bank_mask:0xf
    v_add_f32_dpp v71, v71, v71 row_bcast:31 row_mask:0xc bank_mask:0xf
    v_mul_f32 v68, 0xbfb8aa3b, v68
    v_mul_f32 v69, 0xbfb8aa3b, v69
    v_mul_f32 v70, 0xbfb8aa3b, v70
    v_mul_f32 v71, 0xbfb8aa3b, v71
    v_exp_f32 v68, v68
    v_exp_f32 v69, v69
    v_exp_f32 v70, v70
    v_exp_f32 v71, v71
    v_add_f32 v68, 1.0, v68
    v_add_f32 v69, 1.0, v69
    v_add_f32 v70, 1.0, v70
    v_add_f32 v71, 1.0, v71
    v_rcp_f32 v68, v68
    v_rcp_f32 v69, v69
    v_rcp_f32 v70, v70
    v_rcp_f32 v71, v71
    v_lshlrev_b32 v3, 1, v1
    v_add_u32 v3, 29024, v3
    v_add_u32 v4, 76288, v3
    s_lshl_b32 s13, s61, 13
    v_lshlrev_b32 v5, 7, v0
    v_add_u32 v5, s13, v5
    s_lshl_b32 s10, s14, 2
    s_add_u32 s10, s10, 0x410000
    v_mov_b32 v10, s10
    s_mov_b32 s13, 786432
    buffer_load_dwordx2 v[22:23], v2, s[48:51], s13 offen
    s_waitcnt vmcnt(3)
    ds_write_b16 v3, v16 offset:0
    ds_write_b16_d16_hi v3, v16 offset:38144
    ds_write_b16 v4, v17 offset:0
    ds_write_b16_d16_hi v4, v17 offset:38144
    s_waitcnt lgkmcnt(0)
    s_barrier
    s_mov_b32 s13, 1048576
    buffer_load_dwordx2 v[24:25], v2, s[48:51], s13 offen
    s_waitcnt vmcnt(3)
    ds_write_b16 v3, v18 offset:512
    ds_write_b16_d16_hi v3, v18 offset:38656
    ds_write_b16 v4, v19 offset:512
    ds_write_b16_d16_hi v4, v19 offset:38656
    s_waitcnt lgkmcnt(0)
    s_barrier
    s_mov_b32 s13, 1310720
    buffer_load_dwordx2 v[26:27], v2, s[48:51], s13 offen
    s_waitcnt vmcnt(3)
    ds_write_b16 v3, v20 offset:1024
    ds_write_b16_d16_hi v3, v20 offset:39168
    ds_write_b16 v4, v21 offset:1024
    ds_write_b16_d16_hi v4, v21 offset:39168
    s_waitcnt lgkmcnt(0)
    s_barrier
    s_mov_b32 s13, 1572864
    buffer_load_dwordx2 v[28:29], v2, s[48:51], s13 offen
    s_waitcnt vmcnt(3)
    ds_write_b16 v3, v22 offset:1536
    ds_write_b16_d16_hi v3, v22 offset:39680
    ds_write_b16 v4, v23 offset:1536
    ds_write_b16_d16_hi v4, v23 offset:39680
    s_waitcnt lgkmcnt(0)
    s_barrier
    s_mov_b32 s13, 1835008
    buffer_load_dwordx2 v[30:31], v2, s[48:51], s13 offen
    global_load_dword v46, v5, s[20:21]
    s_mov_b32 exec_lo, 0
    s_mov_b32 exec_hi, 0x80000000
    buffer_store_dwordx4 v[68:71], v10, s[56:59], 0 offen sc1
    s_mov_b64 exec, -1
    s_waitcnt vmcnt(5)
    ds_write_b16 v3, v24 offset:2048
    ds_write_b16_d16_hi v3, v24 offset:40192
    ds_write_b16 v4, v25 offset:2048
    ds_write_b16_d16_hi v4, v25 offset:40192
    s_waitcnt lgkmcnt(0)
    s_barrier
    s_waitcnt vmcnt(4)
    ds_write_b16 v3, v26 offset:2560
    ds_write_b16_d16_hi v3, v26 offset:40704
    ds_write_b16 v4, v27 offset:2560
    ds_write_b16_d16_hi v4, v27 offset:40704
    s_waitcnt lgkmcnt(0)
    s_barrier
    s_waitcnt vmcnt(3)
    ds_write_b16 v3, v28 offset:3072
    ds_write_b16_d16_hi v3, v28 offset:41216
    ds_write_b16 v4, v29 offset:3072
    ds_write_b16_d16_hi v4, v29 offset:41216
    s_waitcnt lgkmcnt(0)
    s_barrier
    s_waitcnt vmcnt(2)
    ds_write_b16 v3, v30 offset:3584
    ds_write_b16_d16_hi v3, v30 offset:41728
    ds_write_b16 v4, v31 offset:3584
    ds_write_b16_d16_hi v4, v31 offset:41728
    s_waitcnt lgkmcnt(0)
    s_barrier
    s_load_dwordx8 s[84:91], s[44:45], 0
    s_waitcnt lgkmcnt(0)
    s_and_b64 s[84:85], s[84:85], s[86:87]
    s_and_b64 s[88:89], s[88:89], s[90:91]
    s_and_b64 s[84:85], s[84:85], s[88:89]
    s_and_b32 s84, s84, s85
    s_cbranch_scc1 INIT_OK_H
    v_and_b32 v6, 7, v0
    v_lshlrev_b32 v6, 2, v6
    s_mov_b32 s84, 0
INIT_POLL_H:
    global_load_dword v7, v6, s[44:45] sc1
    s_waitcnt vmcnt(0)
    v_cmp_eq_u32 vcc, 0, v7
    s_cbranch_vccz INIT_OK_H
    s_add_u32 s84, s84, 1
    s_cmp_gt_u32 s84, 0x40000
    s_cbranch_scc1 INIT_OK_H
    s_sleep 8
    s_branch INIT_POLL_H
INIT_OK_H:
    s_add_u32 s92, s4, 8
    s_branch K_SYNC
K1_SSMC:
    v_lshlrev_b32 v2, 4, v0
    s_add_u32 s60, s62, K1_TABLE-K1_PC0
    s_addc_u32 s61, s63, 0
    global_load_dwordx4 v[244:247], v2, s[60:61] offset:0
    global_load_dwordx4 v[240:243], v2, s[60:61] offset:1024
    global_load_dwordx4 v[236:239], v2, s[60:61] offset:2048
    s_mov_b32 s56, s46
    s_mov_b32 s57, s47
    s_mov_b32 s58, 0x600000
    s_mov_b32 s59, 0x20000
    s_mul_i32 s8, s3, 38144
    v_mov_b32 v16, 0
    v_mov_b32 v17, 0
    v_mov_b32 v18, 0
    v_mov_b32 v19, 0
    v_lshlrev_b32 v3, 4, v0
    v_add_u32 v3, s8, v3
    ds_write_b128 v3, v[16:19] offset:33120
    ds_write_b128 v3, v[16:19] offset:34144
    ds_write_b128 v3, v[16:19] offset:35168
    ds_write_b128 v3, v[16:19] offset:36192
    ds_write_b128 v3, v[16:19] offset:37120
    v_lshlrev_b32 v3, 3, v0
    v_add_u32 v3, s8, v3
    ds_write_b64 v3, v[16:17] offset:28512
    s_waitcnt vmcnt(10)
    v_mul_f32 v10, 0x3fb8aa3b, v10
    v_exp_f32 v10, v10
    s_nop 0
    v_cvt_pk_bf16_f32 v10, v10, v10
    v_and_b32 v10, 0xffff0000, v10
    s_waitcnt vmcnt(8)
    v_lshlrev_b32 v20, 16, v4
    v_and_b32 v21, 0xffff0000, v4
    v_lshlrev_b32 v22, 16, v5
    v_and_b32 v23, 0xffff0000, v5
    v_mul_f32 v20, v10, v20
    v_mul_f32 v21, v10, v21
    v_mul_f32 v22, v10, v22
    v_mul_f32 v23, v10, v23
    v_mul_f32 v32, 0x3fb8aa3b, v20
    v_mul_f32 v34, 0x3e22f983, v22
    v_mul_f32 v33, 0x3fb8aa3b, v21
    v_mul_f32 v35, 0x3e22f983, v23
    v_mul_f32 v36, 0x43b8aa3b, v20
    v_mul_f32 v38, 0x4222f983, v22
    v_mul_f32 v37, 0x43b8aa3b, v21
    v_mul_f32 v39, 0x4222f983, v23
    v_exp_f32 v32, v32
    v_fract_f32 v34, v34
    v_exp_f32 v33, v33
    v_fract_f32 v35, v35
    v_exp_f32 v36, v36
    v_fract_f32 v38, v38
    v_exp_f32 v37, v37
    v_fract_f32 v39, v39
    v_cos_f32 v136, v34
    v_sin_f32 v137, v34
    v_cos_f32 v138, v35
    v_sin_f32 v139, v35
    v_cos_f32 v144, v38
    v_sin_f32 v145, v38
    v_cos_f32 v146, v39
    v_sin_f32 v147, v39
    v_mul_f32 v136, v32, v136
    v_mul_f32 v137, v32, v137
    v_mul_f32 v138, v33, v138
    v_mul_f32 v139, v33, v139
    v_mul_f32 v144, v36, v144
    v_mul_f32 v145, v36, v145
    v_mul_f32 v146, v37, v146
    v_mul_f32 v147, v37, v147
    s_waitcnt vmcnt(4)
    v_lshlrev_b32 v24, 16, v6
    v_and_b32 v25, 0xffff0000, v6
    v_lshlrev_b32 v26, 16, v7
    v_and_b32 v27, 0xffff0000, v7
    v_lshlrev_b32 v28, 16, v8
    v_and_b32 v29, 0xffff0000, v8
    v_lshlrev_b32 v30, 16, v9
    v_and_b32 v31, 0xffff0000, v9
    v_mul_f32 v24, v10, v24
    v_mul_f32 v25, v10, v25
    v_mul_f32 v26, v10, v26
    v_mul_f32 v27, v10, v27
    v_mul_f32 v48, v28, v24
    v_mul_f32 v49, v28, v26
    v_fma_f32 v48, -v30, v26, v48
    v_fma_f32 v49, v30, v24, v49
    v_mul_f32 v50, v29, v25
    v_mul_f32 v51, v29, v27
    v_fma_f32 v50, -v31, v27, v50
    v_fma_f32 v51, v31, v25, v51
    v_pk_mul_f32 v[52:53], v[48:49], v[136:137] op_sel:[0,0] op_sel_hi:[1,0]
    v_pk_mul_f32 v[54:55], v[50:51], v[138:139] op_sel:[0,0] op_sel_hi:[1,0]
    v_pk_fma_f32 v[52:53], v[48:49], v[136:137], v[52:53] op_sel:[1,1,0] op_sel_hi:[0,1,1] neg_lo:[1,0,0]
    v_pk_fma_f32 v[54:55], v[50:51], v[138:139], v[54:55] op_sel:[1,1,0] op_sel_hi:[0,1,1] neg_lo:[1,0,0]
    v_pk_mul_f32 v[56:57], v[52:53], v[136:137] op_sel:[0,0] op_sel_hi:[1,0]
    v_pk_mul_f32 v[58:59], v[54:55], v[138:139] op_sel:[0,0] op_sel_hi:[1,0]
    v_cvt_pk_bf16_f32 v168, v48, v49
    v_pk_fma_f32 v[56:57], v[52:53], v[136:137], v[56:57] op_sel:[1,1,0] op_sel_hi:[0,1,1] neg_lo:[1,0,0]
    v_pk_fma_f32 v[58:59], v[54:55], v[138:139], v[58:59] op_sel:[1,1,0] op_sel_hi:[0,1,1] neg_lo:[1,0,0]
    v_cvt_pk_bf16_f32 v169, v50, v51
    v_pk_mul_f32 v[60:61], v[56:57], v[136:137] op_sel:[0,0] op_sel_hi:[1,0]
    v_pk_mul_f32 v[62:63], v[58:59], v[138:139] op_sel:[0,0] op_sel_hi:[1,0]
    v_cvt_pk_bf16_f32 v170, v52, v53
    v_pk_fma_f32 v[60:61], v[56:57], v[136:137], v[60:61] op_sel:[1,1,0] op_sel_hi:[0,1,1] neg_lo:[1,0,0]
    v_pk_fma_f32 v[62:63], v[58:59], v[138:139], v[62:63] op_sel:[1,1,0] op_sel_hi:[0,1,1] neg_lo:[1,0,0]
    v_cvt_pk_bf16_f32 v171, v54, v55
    ds_write2_b64 v3, v[168:169], v[170:171] offset0:0 offset1:66
    v_pk_mul_f32 v[64:65], v[60:61], v[136:137] op_sel:[0,0] op_sel_hi:[1,0]
    v_pk_mul_f32 v[66:67], v[62:63], v[138:139] op_sel:[0,0] op_sel_hi:[1,0]
    v_cvt_pk_bf16_f32 v172, v56, v57
    v_pk_fma_f32 v[64:65], v[60:61], v[136:137], v[64:65] op_sel:[1,1,0] op_sel_hi:[0,1,1] neg_lo:[1,0,0]
    v_pk_fma_f32 v[66:67], v[62:63], v[138:139], v[66:67] op_sel:[1,1,0] op_sel_hi:[0,1,1] neg_lo:[1,0,0]
    v_cvt_pk_bf16_f32 v173, v58, v59
    v_pk_mul_f32 v[68:69], v[64:65], v[136:137] op_sel:[0,0] op_sel_hi:[1,0]
    v_pk_mul_f32 v[70:71], v[66:67], v[138:139] op_sel:[0,0] op_sel_hi:[1,0]
    v_cvt_pk_bf16_f32 v174, v60, v61
    v_pk_fma_f32 v[68:69], v[64:65], v[136:137], v[68:69] op_sel:[1,1,0] op_sel_hi:[0,1,1] neg_lo:[1,0,0]
    v_pk_fma_f32 v[70:71], v[66:67], v[138:139], v[70:71] op_sel:[1,1,0] op_sel_hi:[0,1,1] neg_lo:[1,0,0]
    v_cvt_pk_bf16_f32 v175, v62, v63
    ds_write2_b64 v3, v[172:173], v[174:175] offset0:132 offset1:198
    v_add_u32 v3, 2112, v3
    v_pk_mul_f32 v[72:73], v[68:69], v[136:137] op_sel:[0,0] op_sel_hi:[1,0]
    v_pk_mul_f32 v[74:75], v[70:71], v[138:139] op_sel:[0,0] op_sel_hi:[1,0]
    v_cvt_pk_bf16_f32 v168, v64, v65
    v_pk_fma_f32 v[72:73], v[68:69], v[136:137], v[72:73] op_sel:[1,1,0] op_sel_hi:[0,1,1] neg_lo:[1,0,0]
    v_pk_fma_f32 v[74:75], v[70:71], v[138:139], v[74:75] op_sel:[1,1,0] op_sel_hi:[0,1,1] neg_lo:[1,0,0]
    v_cvt_pk_bf16_f32 v169, v66, v67
    v_pk_mul_f32 v[76:77], v[72:73], v[136:137] op_sel:[0,0] op_sel_hi:[1,0]
    v_pk_mul_f32 v[78:79], v[74:75], v[138:139] op_sel:[0,0] op_sel_hi:[1,0]
    v_cvt_pk_bf16_f32 v170, v68, v69
    v_pk_fma_f32 v[76:77], v[72:73], v[136:137], v[76:77] op_sel:[1,1,0] op_sel_hi:[0,1,1] neg_lo:[1,0,0]
    v_pk_fma_f32 v[78:79], v[74:75], v[138:139], v[78:79] op_sel:[1,1,0] op_sel_hi:[0,1,1] neg_lo:[1,0,0]
    v_cvt_pk_bf16_f32 v171, v70, v71
    ds_write2_b64 v3, v[168:169], v[170:171] offset0:0 offset1:66
    v_pk_mul_f32 v[80:81], v[76:77], v[136:137] op_sel:[0,0] op_sel_hi:[1,0]
    v_pk_mul_f32 v[82:83], v[78:79], v[138:139] op_sel:[0,0] op_sel_hi:[1,0]
    v_cvt_pk_bf16_f32 v172, v72, v73
    v_pk_fma_f32 v[80:81], v[76:77], v[136:137], v[80:81] op_sel:[1,1,0] op_sel_hi:[0,1,1] neg_lo:[1,0,0]
    v_pk_fma_f32 v[82:83], v[78:79], v[138:139], v[82:83] op_sel:[1,1,0] op_sel_hi:[0,1,1] neg_lo:[1,0,0]
    v_cvt_pk_bf16_f32 v173, v74, v75
    v_pk_mul_f32 v[84:85], v[48:49], v[144:145] op_sel:[0,0] op_sel_hi:[1,0]
    v_pk_mul_f32 v[86:87], v[50:51], v[146:147] op_sel:[0,0] op_sel_hi:[1,0]
    v_cvt_pk_bf16_f32 v174, v76, v77
    v_pk_fma_f32 v[84:85], v[48:49], v[144:145], v[84:85] op_sel:[1,1,0] op_sel_hi:[0,1,1] neg_lo:[1,0,0]
    v_pk_fma_f32 v[86:87], v[50:51], v[146:147], v[86:87] op_sel:[1,1,0] op_sel_hi:[0,1,1] neg_lo:[1,0,0]
    v_cvt_pk_bf16_f32 v175, v78, v79
    ds_write2_b64 v3, v[172:173], v[174:175] offset0:132 offset1:198
    v_add_u32 v3, 2112, v3
    v_pk_mul_f32 v[88:89], v[56:57], v[144:145] op_sel:[0,0] op_sel_hi:[1,0]
    v_pk_mul_f32 v[90:91], v[58:59], v[146:147] op_sel:[0,0] op_sel_hi:[1,0]
    v_cvt_pk_bf16_f32 v168, v80, v81
    v_pk_fma_f32 v[88:89], v[56:57], v[144:145], v[88:89] op_sel:[1,1,0] op_sel_hi:[0,1,1] neg_lo:[1,0,0]
    v_pk_fma_f32 v[90:91], v[58:59], v[146:147], v[90:91] op_sel:[1,1,0] op_sel_hi:[0,1,1] neg_lo:[1,0,0]
    v_cvt_pk_bf16_f32 v169, v82, v83
    v_pk_mul_f32 v[92:93], v[64:65], v[144:145] op_sel:[0,0] op_sel_hi:[1,0]
    v_pk_mul_f32 v[94:95], v[66:67], v[146:147] op_sel:[0,0] op_sel_hi:[1,0]
    v_cvt_pk_bf16_f32 v170, v84, v85
    v_pk_fma_f32 v[92:93], v[64:65], v[144:145], v[92:93] op_sel:[1,1,0] op_sel_hi:[0,1,1] neg_lo:[1,0,0]
    v_pk_fma_f32 v[94:95], v[66:67], v[146:147], v[94:95] op_sel:[1,1,0] op_sel_hi:[0,1,1] neg_lo:[1,0,0]
    v_cvt_pk_bf16_f32 v171, v86, v87
    ds_write2_b64 v3, v[168:169], v[170:171] offset0:0 offset1:66
    v_pk_mul_f32 v[96:97], v[72:73], v[144:145] op_sel:[0,0] op_sel_hi:[1,0]
    v_pk_mul_f32 v[98:99], v[74:75], v[146:147] op_sel:[0,0] op_sel_hi:[1,0]
    v_cvt_pk_bf16_f32 v172, v88, v89
    v_pk_fma_f32 v[96:97], v[72:73], v[144:145], v[96:97] op_sel:[1,1,0] op_sel_hi:[0,1,1] neg_lo:[1,0,0]
    v_pk_fma_f32 v[98:99], v[74:75], v[146:147], v[98:99] op_sel:[1,1,0] op_sel_hi:[0,1,1] neg_lo:[1,0,0]
    v_cvt_pk_bf16_f32 v173, v90, v91
    v_pk_mul_f32 v[100:101], v[80:81], v[144:145] op_sel:[0,0] op_sel_hi:[1,0]
    v_pk_mul_f32 v[102:103], v[82:83], v[146:147] op_sel:[0,0] op_sel_hi:[1,0]
    v_cvt_pk_bf16_f32 v174, v92, v93
    v_pk_fma_f32 v[100:101], v[80:81], v[144:145], v[100:101] op_sel:[1,1,0] op_sel_hi:[0,1,1] neg_lo:[1,0,0]
    v_pk_fma_f32 v[102:103], v[82:83], v[146:147], v[102:103] op_sel:[1,1,0] op_sel_hi:[0,1,1] neg_lo:[1,0,0]
    v_cvt_pk_bf16_f32 v175, v94, v95
    ds_write2_b64 v3, v[172:173], v[174:175] offset0:132 offset1:198
    v_add_u32 v3, 2112, v3
    v_pk_mul_f32 v[104:105], v[92:93], v[144:145] op_sel:[0,0] op_sel_hi:[1,0]
    v_pk_mul_f32 v[106:107], v[94:95], v[146:147] op_sel:[0,0] op_sel_hi:[1,0]
    v_cvt_pk_bf16_f32 v168, v96, v97
    v_pk_fma_f32 v[104:105], v[92:93], v[144:145], v[104:105] op_sel:[1,1,0] op_sel_hi:[0,1,1] neg_lo:[1,0,0]
    v_pk_fma_f32 v[106:107], v[94:95], v[146:147], v[106:107] op_sel:[1,1,0] op_sel_hi:[0,1,1] neg_lo:[1,0,0]
    v_cvt_pk_bf16_f32 v169, v98, v99
    v_pk_mul_f32 v[108:109], v[100:101], v[144:145] op_sel:[0,0] op_sel_hi:[1,0]
    v_pk_mul_f32 v[110:111], v[102:103], v[146:147] op_sel:[0,0] op_sel_hi:[1,0]
    v_cvt_pk_bf16_f32 v170, v100, v101
    v_pk_fma_f32 v[108:109], v[100:101], v[144:145], v[108:109] op_sel:[1,1,0] op_sel_hi:[0,1,1] neg_lo:[1,0,0]
    v_pk_fma_f32 v[110:111], v[102:103], v[146:147], v[110:111] op_sel:[1,1,0] op_sel_hi:[0,1,1] neg_lo:[1,0,0]
    v_cvt_pk_bf16_f32 v171, v102, v103
    ds_write2_b64 v3, v[168:169], v[170:171] offset0:0 offset1:66
    v_pk_mul_f32 v[112:113], v[104:105], v[144:145] op_sel:[0,0] op_sel_hi:[1,0]
    v_pk_mul_f32 v[114:115], v[106:107], v[146:147] op_sel:[0,0] op_sel_hi:[1,0]
    v_cvt_pk_bf16_f32 v172, v104, v105
    v_pk_fma_f32 v[112:113], v[104:105], v[144:145], v[112:113] op_sel:[1,1,0] op_sel_hi:[0,1,1] neg_lo:[1,0,0]
    v_pk_fma_f32 v[114:115], v[106:107], v[146:147], v[114:115] op_sel:[1,1,0] op_sel_hi:[0,1,1] neg_lo:[1,0,0]
    v_cvt_pk_bf16_f32 v173, v106, v107
    v_pk_mul_f32 v[116:117], v[108:109], v[144:145] op_sel:[0,0] op_sel_hi:[1,0]
    v_pk_mul_f32 v[118:119], v[110:111], v[146:147] op_sel:[0,0] op_sel_hi:[1,0]
    v_cvt_pk_bf16_f32 v174, v108, v109
    v_pk_fma_f32 v[116:117], v[108:109], v[144:145], v[116:117] op_sel:[1,1,0] op_sel_hi:[0,1,1] neg_lo:[1,0,0]
    v_pk_fma_f32 v[118:119], v[110:111], v[146:147], v[118:119] op_sel:[1,1,0] op_sel_hi:[0,1,1] neg_lo:[1,0,0]
    v_cvt_pk_bf16_f32 v175, v110, v111
    ds_write2_b64 v3, v[172:173], v[174:175] offset0:132 offset1:198
    v_add_u32 v3, 2112, v3
    v_pk_mul_f32 v[120:121], v[116:117], v[144:145] op_sel:[0,0] op_sel_hi:[1,0]
    v_pk_mul_f32 v[122:123], v[118:119], v[146:147] op_sel:[0,0] op_sel_hi:[1,0]
    v_cvt_pk_bf16_f32 v168, v112, v113
    v_pk_fma_f32 v[120:121], v[116:117], v[144:145], v[120:121] op_sel:[1,1,0] op_sel_hi:[0,1,1] neg_lo:[1,0,0]
    v_pk_fma_f32 v[122:123], v[118:119], v[146:147], v[122:123] op_sel:[1,1,0] op_sel_hi:[0,1,1] neg_lo:[1,0,0]
    v_cvt_pk_bf16_f32 v169, v114, v115
    v_pk_mul_f32 v[124:125], v[120:121], v[144:145] op_sel:[0,0] op_sel_hi:[1,0]
    v_pk_mul_f32 v[126:127], v[122:123], v[146:147] op_sel:[0,0] op_sel_hi:[1,0]
    v_cvt_pk_bf16_f32 v170, v116, v117
    v_pk_fma_f32 v[124:125], v[120:121], v[144:145], v[124:125] op_sel:[1,1,0] op_sel_hi:[0,1,1] neg_lo:[1,0,0]
    v_pk_fma_f32 v[126:127], v[122:123], v[146:147], v[126:127] op_sel:[1,1,0] op_sel_hi:[0,1,1] neg_lo:[1,0,0]
    v_cvt_pk_bf16_f32 v171, v118, v119
    ds_write2_b64 v3, v[168:169], v[170:171] offset0:0 offset1:66
    v_pk_mul_f32 v[128:129], v[124:125], v[144:145] op_sel:[0,0] op_sel_hi:[1,0]
    v_pk_mul_f32 v[130:131], v[126:127], v[146:147] op_sel:[0,0] op_sel_hi:[1,0]
    v_cvt_pk_bf16_f32 v172, v120, v121
    v_pk_fma_f32 v[128:129], v[124:125], v[144:145], v[128:129] op_sel:[1,1,0] op_sel_hi:[0,1,1] neg_lo:[1,0,0]
    v_pk_fma_f32 v[130:131], v[126:127], v[146:147], v[130:131] op_sel:[1,1,0] op_sel_hi:[0,1,1] neg_lo:[1,0,0]
    v_cvt_pk_bf16_f32 v173, v122, v123
    v_pk_mul_f32 v[132:133], v[128:129], v[144:145] op_sel:[0,0] op_sel_hi:[1,0]
    v_pk_mul_f32 v[134:135], v[130:131], v[146:147] op_sel:[0,0] op_sel_hi:[1,0]
    v_cvt_pk_bf16_f32 v174, v124, v125
    v_pk_fma_f32 v[132:133], v[128:129], v[144:145], v[132:133] op_sel:[1,1,0] op_sel_hi:[0,1,1] neg_lo:[1,0,0]
    v_pk_fma_f32 v[134:135], v[130:131], v[146:147], v[134:135] op_sel:[1,1,0] op_sel_hi:[0,1,1] neg_lo:[1,0,0]
    v_cvt_pk_bf16_f32 v175, v126, v127
    ds_write2_b64 v3, v[172:173], v[174:175] offset0:132 offset1:198
    v_add_u32 v3, 2112, v3
    v_cvt_pk_bf16_f32 v168, v128, v129
    v_cvt_pk_bf16_f32 v169, v130, v131
    v_cvt_pk_bf16_f32 v170, v132, v133
    v_cvt_pk_bf16_f32 v171, v134, v135
    ds_write2_b64 v3, v[168:169], v[170:171] offset0:0 offset1:66
    global_load_dwordx4 v[212:215], v2, s[60:61] offset:3072
    v_add_u32 v2, 4096, v2
    global_load_dwordx4 v[216:219], v2, s[60:61] offset:0
    global_load_dwordx4 v[220:223], v2, s[60:61] offset:1024
    global_load_dwordx4 v[224:227], v2, s[60:61] offset:2048
    global_load_dwordx4 v[228:231], v2, s[60:61] offset:3072
    v_add_u32 v2, 4096, v2
    global_load_dwordx4 v[232:235], v2, s[60:61] offset:0
    s_waitcnt vmcnt(6)
    v_add_u32 v244, s8, v244
    v_add_u32 v245, s8, v245
    v_add_u32 v246, s8, v246
    v_add_u32 v247, s8, v247
    v_add_u32 v240, s8, v240
    v_add_u32 v241, s8, v241
    v_add_u32 v242, s8, v242
    v_add_u32 v243, s8, v243
    v_and_b32 v4, 31, v0
    v_mul_u32_u24 v4, 528, v4
    v_lshrrev_b32 v5, 5, v0
    v_lshl_add_u32 v4, v5, 4, v4
    v_add_u32 v4, s8, v4
    s_waitcnt lgkmcnt(0)
    s_barrier
    ds_read_b128 v[40:43], v244 offset:0
    ds_read_b128 v[44:47], v4 offset:11616
    ds_read_b128 v[48:51], v244 offset:32
    ds_read_b128 v[52:55], v4 offset:11648
    ds_read_b128 v[56:59], v244 offset:64
    ds_read_b128 v[60:63], v4 offset:11680
    ds_read_b128 v[64:67], v244 offset:96
    ds_read_b128 v[68:71], v4 offset:11712
    ds_read_b128 v[72:75], v244 offset:128
    ds_read_b128 v[76:79], v4 offset:11744
    s_waitcnt lgkmcnt(8)
    v_mfma_f32_32x32x16_bf16 v[16:31], v[40:43], v[44:47], 0
    ds_read_b128 v[80:83], v244 offset:160
    ds_read_b128 v[84:87], v4 offset:11776
    s_waitcnt lgkmcnt(8)
    v_mfma_f32_32x32x16_bf16 v[16:31], v[48:51], v[52:55], v[16:31]
    ds_read_b128 v[88:91], v244 offset:192
    ds_read_b128 v[92:95], v4 offset:11808
    s_waitcnt lgkmcnt(8)
    v_mfma_f32_32x32x16_bf16 v[16:31], v[56:59], v[60:63], v[16:31]
    ds_read_b128 v[96:99], v244 offset:224
    ds_read_b128 v[100:103], v4 offset:11840
    s_waitcnt lgkmcnt(8)
    v_mfma_f32_32x32x16_bf16 v[16:31], v[64:67], v[68:71], v[16:31]
    ds_read_b128 v[104:107], v244 offset:256
    ds_read_b128 v[108:111], v4 offset:11872
    s_waitcnt lgkmcnt(8)
    v_mfma_f32_32x32x16_bf16 v[16:31], v[72:75], v[76:79], v[16:31]
    ds_read_b128 v[112:115], v244 offset:288
    ds_read_b128 v[116:119], v4 offset:11904
    s_waitcnt lgkmcnt(8)
    v_mfma_f32_32x32x16_bf16 v[16:31], v[80:83], v[84:87], v[16:31]
    ds_read_b128 v[120:123], v244 offset:320
    ds_read_b128 v[124:127], v4 offset:11936
    s_waitcnt lgkmcnt(8)
    v_mfma_f32_32x32x16_bf16 v[16:31], v[88:91], v[92:95], v[16:31]
    ds_read_b128 v[128:131], v244 offset:352
    ds_read_b128 v[132:135], v4 offset:11968
    s_waitcnt lgkmcnt(8)
    v_mfma_f32_32x32x16_bf16 v[16:31], v[96:99], v[100:103], v[16:31]
    ds_read_b128 v[136:139], v244 offset:384
    ds_read_b128 v[140:143], v4 offset:12000
    s_waitcnt lgkmcnt(8)
    v_mfma_f32_32x32x16_bf16 v[16:31], v[104:107], v[108:111], v[16:31]
    ds_read_b128 v[144:147], v244 offset:416
    ds_read_b128 v[148:151], v4 offset:12032
    s_waitcnt lgkmcnt(8)
    v_mfma_f32_32x32x16_bf16 v[16:31], v[112:115], v[116:119], v[16:31]
    ds_read_b128 v[152:155], v244 offset:448
    ds_read_b128 v[156:159], v4 offset:12064
    s_waitcnt lgkmcnt(8)
    v_mfma_f32_32x32x16_bf16 v[16:31], v[120:123], v[124:127], v[16:31]
    ds_read_b128 v[160:163], v244 offset:480
    ds_read_b128 v[164:167], v4 offset:12096
    s_waitcnt lgkmcnt(8)
    v_mfma_f32_32x32x16_bf16 v[16:31], v[128:131], v[132:135], v[16:31]
    s_mov_b64 s[14:15], 1
    v_cndmask_b32_e64 v5, 0, v252, s[14:15]
    v_lshlrev_b32 v6, 4, v0
    v_sub_u32 v6, 34208, v6
    v_add_u32 v6, s8, v6
    v_mov_b32 v7, s8
    s_waitcnt lgkmcnt(6)
    v_mfma_f32_32x32x16_bf16 v[16:31], v[136:139], v[140:143], v[16:31]
    s_waitcnt lgkmcnt(4)
    v_mfma_f32_32x32x16_bf16 v[16:31], v[144:147], v[148:151], v[16:31]
    s_waitcnt lgkmcnt(2)
    v_mfma_f32_32x32x16_bf16 v[16:31], v[152:155], v[156:159], v[16:31]
    s_waitcnt lgkmcnt(0)
    v_mfma_f32_32x32x16_bf16 v[16:31], v[160:163], v[164:167], v[16:31]
    s_lshl_b32 s9, s7, 12
    s_add_u32 s9, s9, 0x200000
    v_and_b32 v1, 15, v0
    v_lshrrev_b32 v2, 4, v0
    v_lshlrev_b32 v1, 5, v1
    v_lshl_add_u32 v1, v2, 3, v1
    v_add_u32 v8, 512, v245
    v_add_u32 v9, 1024, v245
    v_add_u32 v2, 768, v246
    s_nop 2
    v_add_f32 v16, v16, v5
    v_cvt_pk_bf16_f32 v40, v23, v22
    v_cvt_pk_bf16_f32 v41, v21, v20
    v_cvt_pk_bf16_f32 v42, v19, v18
    v_cvt_pk_bf16_f32 v43, v17, v16
    ds_write_b128 v6, v[40:43]
    v_cvt_pk_bf16_f32 v44, v24, v23
    v_cvt_pk_bf16_f32 v45, v22, v21
    v_cvt_pk_bf16_f32 v46, v20, v19
    v_cvt_pk_bf16_f32 v47, v18, v17
    ds_write_b128 v6, v[44:47] offset:1216
    v_cvt_pk_bf16_f32 v52, v24, v24
    s_mov_b64 exec, 1
    ds_write_b16_d16_hi v7, v43 offset:35440
    s_mov_b32 exec_lo, 0
    s_mov_b32 exec_hi, 0x80000000
    ds_write_b32 v7, v52 offset:33196
    ds_write_b16 v7, v52 offset:33194
    ds_write_b32 v7, v52 offset:34412
    s_mov_b64 exec, -1
    v_cvt_pk_bf16_f32 v48, v25, v25
    v_cvt_pk_bf16_f32 v49, v26, v26
    v_cvt_pk_bf16_f32 v50, v27, v27
    v_cvt_pk_bf16_f32 v51, v28, v28
    ds_write_b16 v240, v48
    ds_write_b16 v240, v48 offset:1218
    ds_write_b16 v241, v49
    ds_write_b16 v241, v49 offset:1218
    ds_write_b16 v242, v50
    ds_write_b16 v242, v50 offset:1218
    ds_write_b16 v243, v51
    ds_write_b16 v243, v51 offset:1218
    v_readlane_b32 s15, v51, 31
    s_nop 1
    v_and_b32 v236, s15, v236
    v_and_b32 v237, s15, v237
    v_and_b32 v238, s15, v238
    v_and_b32 v239, s15, v239
    ds_read2_b32 v[56:57], v9 offset0:0 offset1:1
    ds_read2_b32 v[58:59], v9 offset0:2 offset1:3
    ds_read2_b32 v[60:61], v8 offset0:112 offset1:113
    ds_read2_b32 v[62:63], v8 offset0:114 offset1:115
    ds_read2_b32 v[64:65], v8 offset0:96 offset1:97
    ds_read2_b32 v[66:67], v8 offset0:98 offset1:99
    ds_read2_b32 v[68:69], v8 offset0:80 offset1:81
    ds_read2_b32 v[70:71], v8 offset0:82 offset1:83
    ds_read2_b32 v[72:73], v8 offset0:64 offset1:65
    ds_read2_b32 v[74:75], v8 offset0:66 offset1:67
    ds_read2_b32 v[76:77], v8 offset0:48 offset1:49
    ds_read2_b32 v[78:79], v8 offset0:50 offset1:51
    ds_read2_b32 v[80:81], v8 offset0:32 offset1:33
    ds_read2_b32 v[82:83], v8 offset0:34 offset1:35
    ds_read2_b32 v[84:85], v8 offset0:16 offset1:17
    ds_read2_b32 v[86:87], v8 offset0:18 offset1:19
    ds_read2_b32 v[88:89], v8 offset0:0 offset1:1
    ds_read2_b32 v[90:91], v8 offset0:2 offset1:3
    ds_read2_b32 v[92:93], v245 offset0:112 offset1:113
    ds_read2_b32 v[94:95], v245 offset0:114 offset1:115
    ds_read2_b32 v[96:97], v245 offset0:96 offset1:97
    ds_read2_b32 v[98:99], v245 offset0:98 offset1:99
    ds_read2_b32 v[100:101], v245 offset0:80 offset1:81
    ds_read2_b32 v[102:103], v245 offset0:82 offset1:83
    ds_read2_b32 v[104:105], v245 offset0:64 offset1:65
    ds_read2_b32 v[106:107], v245 offset0:66 offset1:67
    ds_read2_b32 v[108:109], v245 offset0:48 offset1:49
    ds_read2_b32 v[110:111], v245 offset0:50 offset1:51
    ds_read2_b32 v[112:113], v245 offset0:32 offset1:33
    ds_read2_b32 v[114:115], v245 offset0:34 offset1:35
    ds_read2_b32 v[116:117], v245 offset0:16 offset1:17
    ds_read2_b32 v[118:119], v245 offset0:18 offset1:19
    ds_read2_b32 v[120:121], v245 offset0:0 offset1:1
    ds_read2_b32 v[122:123], v245 offset0:2 offset1:3
    s_waitcnt vmcnt(0)
    s_barrier
    ds_read_b128 v[12:15], v247 offset:448
    ds_read_b128 v[44:47], v247 offset:432
    ds_read_b128 v[16:19], v247 offset:384
    ds_read_b128 v[20:23], v247 offset:320
    ds_read_b128 v[24:27], v247 offset:256
    ds_read_b128 v[28:31], v247 offset:192
    ds_read_b128 v[32:35], v247 offset:128
    ds_read_b128 v[36:39], v247 offset:64
    ds_read_b128 v[40:43], v247 offset:0
    s_barrier
    s_waitcnt lgkmcnt(0)
    v_mfma_f32_16x16x32_bf16 v[196:199], v[12:15], v[212:215], 0
    v_mfma_f32_16x16x32_bf16 v[200:203], v[12:15], v[216:219], 0
    v_mfma_f32_16x16x32_bf16 v[204:207], v[12:15], v[220:223], 0
    v_mfma_f32_16x16x32_bf16 v[208:211], v[44:47], v[224:227], 0
    v_mfma_f32_16x16x32_bf16 v[48:51], v[12:15], v[228:231], 0
    v_mfma_f32_16x16x32_bf16 v[52:55], v[44:47], v[232:235], 0
    v_mfma_f32_16x16x32_bf16 v[172:175], v[120:123], v[12:15], 0
    v_mfma_f32_16x16x32_bf16 v[180:183], v[236:239], v[12:15], 0
    v_mfma_f32_16x16x32_bf16 v[164:167], v[56:59], v[12:15], 0
    v_mfma_f32_16x16x32_bf16 v[168:171], v[88:91], v[12:15], 0
    ds_read_b128 v[12:15], v247 offset:960
    ds_read_b128 v[44:47], v247 offset:944
    ds_read2_b32 v[124:125], v246 offset0:16 offset1:17
    ds_read2_b32 v[126:127], v246 offset0:64 offset1:65
    ds_read2_b32 v[128:129], v246 offset0:8 offset1:9
    ds_read2_b32 v[130:131], v246 offset0:56 offset1:57
    v_mfma_f32_16x16x32_bf16 v[164:167], v[60:63], v[16:19], v[164:167]
    v_cvt_pk_bf16_f32 v240, v196, v197
    v_mfma_f32_16x16x32_bf16 v[168:171], v[92:95], v[16:19], v[168:171]
    ds_read_b128 v[16:19], v247 offset:896
    ds_read2_b32 v[132:133], v246 offset0:0 offset1:1
    ds_read2_b32 v[134:135], v246 offset0:48 offset1:49
    ds_read2_b32 v[136:137], v246 offset0:112 offset1:113
    ds_read2_b32 v[138:139], v246 offset0:160 offset1:161
    v_cvt_pk_bf16_f32 v241, v198, v199
    v_mfma_f32_16x16x32_bf16 v[164:167], v[64:67], v[20:23], v[164:167]
    v_cvt_pk_bf16_f32 v242, v200, v201
    v_mfma_f32_16x16x32_bf16 v[168:171], v[96:99], v[20:23], v[168:171]
    ds_read_b128 v[20:23], v247 offset:832
    ds_read2_b32 v[140:141], v246 offset0:104 offset1:105
    ds_read2_b32 v[142:143], v246 offset0:152 offset1:153
    ds_read2_b32 v[144:145], v246 offset0:96 offset1:97
    ds_read2_b32 v[146:147], v246 offset0:144 offset1:145
    v_cvt_pk_bf16_f32 v243, v202, v203
    v_mfma_f32_16x16x32_bf16 v[164:167], v[68:71], v[24:27], v[164:167]
    v_cvt_pk_bf16_f32 v248, v204, v205
    v_mfma_f32_16x16x32_bf16 v[168:171], v[100:103], v[24:27], v[168:171]
    ds_read_b128 v[24:27], v247 offset:768
    ds_read2_b32 v[148:149], v2 offset0:24 offset1:25
    ds_read2_b32 v[150:151], v2 offset0:72 offset1:73
    ds_read2_b32 v[152:153], v2 offset0:16 offset1:17
    ds_read2_b32 v[154:155], v2 offset0:64 offset1:65
    v_cvt_pk_bf16_f32 v249, v206, v207
    v_mfma_f32_16x16x32_bf16 v[164:167], v[72:75], v[28:31], v[164:167]
    v_cvt_pk_bf16_f32 v250, v208, v209
    v_mfma_f32_16x16x32_bf16 v[168:171], v[104:107], v[28:31], v[168:171]
    ds_read_b128 v[28:31], v247 offset:704
    ds_read2_b32 v[156:157], v2 offset0:8 offset1:9
    ds_read2_b32 v[158:159], v2 offset0:56 offset1:57
    ds_read2_b32 v[160:161], v2 offset0:0 offset1:1
    ds_read2_b32 v[162:163], v2 offset0:48 offset1:49
    v_cvt_pk_bf16_f32 v251, v210, v211
    v_mfma_f32_16x16x32_bf16 v[164:167], v[76:79], v[32:35], v[164:167]
    v_cvt_pk_bf16_f32 v8, v48, v49
    v_mfma_f32_16x16x32_bf16 v[168:171], v[108:111], v[32:35], v[168:171]
    ds_read_b128 v[32:35], v247 offset:640
    v_cvt_pk_bf16_f32 v9, v50, v51
    v_mfma_f32_16x16x32_bf16 v[164:167], v[80:83], v[36:39], v[164:167]
    v_cvt_pk_bf16_f32 v10, v52, v53
    v_mfma_f32_16x16x32_bf16 v[168:171], v[112:115], v[36:39], v[168:171]
    ds_read_b128 v[36:39], v247 offset:576
    v_cvt_pk_bf16_f32 v11, v54, v55
    v_mfma_f32_16x16x32_bf16 v[164:167], v[84:87], v[40:43], v[164:167]
    v_mfma_f32_16x16x32_bf16 v[168:171], v[116:119], v[40:43], v[168:171]
    ds_read_b128 v[40:43], v247 offset:512
    s_waitcnt lgkmcnt(3)
    v_mfma_f32_16x16x32_bf16 v[172:175], v[240:243], v[124:127], v[172:175]
    v_mfma_f32_16x16x32_bf16 v[176:179], v[240:243], v[128:131], 0
    v_mfma_f32_16x16x32_bf16 v[180:183], v[240:243], v[132:135], v[180:183]
    v_mfma_f32_16x16x32_bf16 v[172:175], v[248:251], v[136:139], v[172:175]
    v_mfma_f32_16x16x32_bf16 v[176:179], v[248:251], v[140:143], v[176:179]
    v_mfma_f32_16x16x32_bf16 v[180:183], v[248:251], v[144:147], v[180:183]
    v_mfma_f32_16x16x32_bf16 v[180:183], v[8:11], v[148:151], v[180:183]
    v_mfma_f32_16x16x32_bf16 v[184:187], v[8:11], v[152:155], 0
    v_mfma_f32_16x16x32_bf16 v[188:191], v[8:11], v[156:159], 0
    v_mfma_f32_16x16x32_bf16 v[192:195], v[8:11], v[160:163], 0
    s_barrier
    s_waitcnt lgkmcnt(0)
    v_mfma_f32_16x16x32_bf16 v[196:199], v[12:15], v[212:215], 0
    v_mfma_f32_16x16x32_bf16 v[200:203], v[12:15], v[216:219], 0
    v_mfma_f32_16x16x32_bf16 v[204:207], v[12:15], v[220:223], 0
    v_mfma_f32_16x16x32_bf16 v[208:211], v[44:47], v[224:227], 0
    v_mfma_f32_16x16x32_bf16 v[48:51], v[12:15], v[228:231], 0
    v_mfma_f32_16x16x32_bf16 v[52:55], v[44:47], v[232:235], 0
    v_mfma_f32_16x16x32_bf16 v[176:179], v[120:123], v[12:15], v[176:179]
    v_mfma_f32_16x16x32_bf16 v[184:187], v[236:239], v[12:15], v[184:187]
    v_mfma_f32_16x16x32_bf16 v[168:171], v[56:59], v[12:15], v[168:171]
    v_mfma_f32_16x16x32_bf16 v[172:175], v[88:91], v[12:15], v[172:175]
    ds_read_b128 v[12:15], v247 offset:1472
    ds_read_b128 v[44:47], v247 offset:1456
    v_mfma_f32_16x16x32_bf16 v[168:171], v[60:63], v[16:19], v[168:171]
    v_cvt_pk_bf16_f32 v240, v196, v197
    v_mfma_f32_16x16x32_bf16 v[172:175], v[92:95], v[16:19], v[172:175]
    ds_read_b128 v[16:19], v247 offset:1408
    v_cvt_pk_bf16_f32 v241, v198, v199
    v_mfma_f32_16x16x32_bf16 v[168:171], v[64:67], v[20:23], v[168:171]
    v_cvt_pk_bf16_f32 v242, v200, v201
    v_mfma_f32_16x16x32_bf16 v[172:175], v[96:99], v[20:23], v[172:175]
    ds_read_b128 v[20:23], v247 offset:1344
    v_cvt_pk_bf16_f32 v243, v202, v203
    v_mfma_f32_16x16x32_bf16 v[168:171], v[68:71], v[24:27], v[168:171]
    v_cvt_pk_bf16_f32 v248, v204, v205
    v_mfma_f32_16x16x32_bf16 v[172:175], v[100:103], v[24:27], v[172:175]
    ds_read_b128 v[24:27], v247 offset:1280
    v_cvt_pk_bf16_f32 v249, v206, v207
    v_mfma_f32_16x16x32_bf16 v[168:171], v[72:75], v[28:31], v[168:171]
    v_cvt_pk_bf16_f32 v250, v208, v209
    v_mfma_f32_16x16x32_bf16 v[172:175], v[104:107], v[28:31], v[172:175]
    ds_read_b128 v[28:31], v247 offset:1216
    v_cvt_pk_bf16_f32 v251, v210, v211
    v_mfma_f32_16x16x32_bf16 v[168:171], v[76:79], v[32:35], v[168:171]
    v_cvt_pk_bf16_f32 v8, v48, v49
    v_mfma_f32_16x16x32_bf16 v[172:175], v[108:111], v[32:35], v[172:175]
    ds_read_b128 v[32:35], v247 offset:1152
    v_cvt_pk_bf16_f32 v9, v50, v51
    v_mfma_f32_16x16x32_bf16 v[168:171], v[80:83], v[36:39], v[168:171]
    v_cvt_pk_bf16_f32 v10, v52, v53
    v_mfma_f32_16x16x32_bf16 v[172:175], v[112:115], v[36:39], v[172:175]
    ds_read_b128 v[36:39], v247 offset:1088
    v_cvt_pk_bf16_f32 v11, v54, v55
    v_mfma_f32_16x16x32_bf16 v[168:171], v[84:87], v[40:43], v[168:171]
    v_mfma_f32_16x16x32_bf16 v[172:175], v[116:119], v[40:43], v[172:175]
    ds_read_b128 v[40:43], v247 offset:1024
    v_mfma_f32_16x16x32_bf16 v[176:179], v[240:243], v[124:127], v[176:179]
    v_cvt_pk_bf16_f32 v6, v164, v165
    v_mfma_f32_16x16x32_bf16 v[180:183], v[240:243], v[128:131], v[180:183]
    v_cvt_pk_bf16_f32 v7, v166, v167
    v_mfma_f32_16x16x32_bf16 v[184:187], v[240:243], v[132:135], v[184:187]
    buffer_store_dwordx2 v[6:7], v1, s[56:59], s9 offen offset:0 sc1
    v_mfma_f32_16x16x32_bf16 v[176:179], v[248:251], v[136:139], v[176:179]
    v_mfma_f32_16x16x32_bf16 v[180:183], v[248:251], v[140:143], v[180:183]
    v_mfma_f32_16x16x32_bf16 v[184:187], v[248:251], v[144:147], v[184:187]
    v_mfma_f32_16x16x32_bf16 v[184:187], v[8:11], v[148:151], v[184:187]
    v_mfma_f32_16x16x32_bf16 v[188:191], v[8:11], v[152:155], v[188:191]
    v_mfma_f32_16x16x32_bf16 v[192:195], v[8:11], v[156:159], v[192:195]
    s_barrier
    s_waitcnt lgkmcnt(0)
    v_mfma_f32_16x16x32_bf16 v[196:199], v[12:15], v[212:215], 0
    v_mfma_f32_16x16x32_bf16 v[200:203], v[12:15], v[216:219], 0
    v_mfma_f32_16x16x32_bf16 v[204:207], v[12:15], v[220:223], 0
    v_mfma_f32_16x16x32_bf16 v[208:211], v[44:47], v[224:227], 0
    v_mfma_f32_16x16x32_bf16 v[48:51], v[12:15], v[228:231], 0
    v_mfma_f32_16x16x32_bf16 v[52:55], v[44:47], v[232:235], 0
    v_mfma_f32_16x16x32_bf16 v[180:183], v[120:123], v[12:15], v[180:183]
    v_mfma_f32_16x16x32_bf16 v[188:191], v[236:239], v[12:15], v[188:191]
    v_mfma_f32_16x16x32_bf16 v[172:175], v[56:59], v[12:15], v[172:175]
    v_mfma_f32_16x16x32_bf16 v[176:179], v[88:91], v[12:15], v[176:179]
    ds_read_b128 v[12:15], v247 offset:1984
    ds_read_b128 v[44:47], v247 offset:1968
    v_mfma_f32_16x16x32_bf16 v[172:175], v[60:63], v[16:19], v[172:175]
    v_cvt_pk_bf16_f32 v240, v196, v197
    v_mfma_f32_16x16x32_bf16 v[176:179], v[92:95], v[16:19], v[176:179]
    ds_read_b128 v[16:19], v247 offset:1920
    v_cvt_pk_bf16_f32 v241, v198, v199
    v_mfma_f32_16x16x32_bf16 v[172:175], v[64:67], v[20:23], v[172:175]
    v_cvt_pk_bf16_f32 v242, v200, v201
    v_mfma_f32_16x16x32_bf16 v[176:179], v[96:99], v[20:23], v[176:179]
    ds_read_b128 v[20:23], v247 offset:1856
    v_cvt_pk_bf16_f32 v243, v202, v203
    v_mfma_f32_16x16x32_bf16 v[172:175], v[68:71], v[24:27], v[172:175]
    v_cvt_pk_bf16_f32 v248, v204, v205
    v_mfma_f32_16x16x32_bf16 v[176:179], v[100:103], v[24:27], v[176:179]
    ds_read_b128 v[24:27], v247 offset:1792
    v_cvt_pk_bf16_f32 v249, v206, v207
    v_mfma_f32_16x16x32_bf16 v[172:175], v[72:75], v[28:31], v[172:175]
    v_cvt_pk_bf16_f32 v250, v208, v209
    v_mfma_f32_16x16x32_bf16 v[176:179], v[104:107], v[28:31], v[176:179]
    ds_read_b128 v[28:31], v247 offset:1728
    v_cvt_pk_bf16_f32 v251, v210, v211
    v_mfma_f32_16x16x32_bf16 v[172:175], v[76:79], v[32:35], v[172:175]
    v_cvt_pk_bf16_f32 v8, v48, v49
    v_mfma_f32_16x16x32_bf16 v[176:179], v[108:111], v[32:35], v[176:179]
    ds_read_b128 v[32:35], v247 offset:1664
    v_cvt_pk_bf16_f32 v9, v50, v51
    v_mfma_f32_16x16x32_bf16 v[172:175], v[80:83], v[36:39], v[172:175]
    v_cvt_pk_bf16_f32 v10, v52, v53
    v_mfma_f32_16x16x32_bf16 v[176:179], v[112:115], v[36:39], v[176:179]
    ds_read_b128 v[36:39], v247 offset:1600
    v_cvt_pk_bf16_f32 v11, v54, v55
    v_mfma_f32_16x16x32_bf16 v[172:175], v[84:87], v[40:43], v[172:175]
    v_mfma_f32_16x16x32_bf16 v[176:179], v[116:119], v[40:43], v[176:179]
    ds_read_b128 v[40:43], v247 offset:1536
    v_mfma_f32_16x16x32_bf16 v[180:183], v[240:243], v[124:127], v[180:183]
    v_cvt_pk_bf16_f32 v6, v168, v169
    v_mfma_f32_16x16x32_bf16 v[184:187], v[240:243], v[128:131], v[184:187]
    v_cvt_pk_bf16_f32 v7, v170, v171
    v_mfma_f32_16x16x32_bf16 v[188:191], v[240:243], v[132:135], v[188:191]
    buffer_store_dwordx2 v[6:7], v1, s[56:59], s9 offen offset:512 sc1
    v_mfma_f32_16x16x32_bf16 v[180:183], v[248:251], v[136:139], v[180:183]
    v_mfma_f32_16x16x32_bf16 v[184:187], v[248:251], v[140:143], v[184:187]
    v_mfma_f32_16x16x32_bf16 v[188:191], v[248:251], v[144:147], v[188:191]
    v_mfma_f32_16x16x32_bf16 v[188:191], v[8:11], v[148:151], v[188:191]
    v_mfma_f32_16x16x32_bf16 v[192:195], v[8:11], v[152:155], v[192:195]
    s_barrier
    s_waitcnt lgkmcnt(0)
    v_mfma_f32_16x16x32_bf16 v[196:199], v[12:15], v[212:215], 0
    v_mfma_f32_16x16x32_bf16 v[200:203], v[12:15], v[216:219], 0
    v_mfma_f32_16x16x32_bf16 v[204:207], v[12:15], v[220:223], 0
    v_mfma_f32_16x16x32_bf16 v[208:211], v[44:47], v[224:227], 0
    v_mfma_f32_16x16x32_bf16 v[48:51], v[12:15], v[228:231], 0
    v_mfma_f32_16x16x32_bf16 v[52:55], v[44:47], v[232:235], 0
    v_mfma_f32_16x16x32_bf16 v[184:187], v[120:123], v[12:15], v[184:187]
    v_mfma_f32_16x16x32_bf16 v[192:195], v[236:239], v[12:15], v[192:195]
    v_mfma_f32_16x16x32_bf16 v[176:179], v[56:59], v[12:15], v[176:179]
    v_mfma_f32_16x16x32_bf16 v[180:183], v[88:91], v[12:15], v[180:183]
    ds_read_b128 v[12:15], v247 offset:2496
    ds_read_b128 v[44:47], v247 offset:2480
    v_mfma_f32_16x16x32_bf16 v[176:179], v[60:63], v[16:19], v[176:179]
    v_cvt_pk_bf16_f32 v240, v196, v197
    v_mfma_f32_16x16x32_bf16 v[180:183], v[92:95], v[16:19], v[180:183]
    ds_read_b128 v[16:19], v247 offset:2432
    v_cvt_pk_bf16_f32 v241, v198, v199
    v_mfma_f32_16x16x32_bf16 v[176:179], v[64:67], v[20:23], v[176:179]
    v_cvt_pk_bf16_f32 v242, v200, v201
    v_mfma_f32_16x16x32_bf16 v[180:183], v[96:99], v[20:23], v[180:183]
    ds_read_b128 v[20:23], v247 offset:2368
    v_cvt_pk_bf16_f32 v243, v202, v203
    v_mfma_f32_16x16x32_bf16 v[176:179], v[68:71], v[24:27], v[176:179]
    v_cvt_pk_bf16_f32 v248, v204, v205
    v_mfma_f32_16x16x32_bf16 v[180:183], v[100:103], v[24:27], v[180:183]
    ds_read_b128 v[24:27], v247 offset:2304
    v_cvt_pk_bf16_f32 v249, v206, v207
    v_mfma_f32_16x16x32_bf16 v[176:179], v[72:75], v[28:31], v[176:179]
    v_cvt_pk_bf16_f32 v250, v208, v209
    v_mfma_f32_16x16x32_bf16 v[180:183], v[104:107], v[28:31], v[180:183]
    ds_read_b128 v[28:31], v247 offset:2240
    v_cvt_pk_bf16_f32 v251, v210, v211
    v_mfma_f32_16x16x32_bf16 v[176:179], v[76:79], v[32:35], v[176:179]
    v_cvt_pk_bf16_f32 v8, v48, v49
    v_mfma_f32_16x16x32_bf16 v[180:183], v[108:111], v[32:35], v[180:183]
    ds_read_b128 v[32:35], v247 offset:2176
    v_cvt_pk_bf16_f32 v9, v50, v51
    v_mfma_f32_16x16x32_bf16 v[176:179], v[80:83], v[36:39], v[176:179]
    v_cvt_pk_bf16_f32 v10, v52, v53
    v_mfma_f32_16x16x32_bf16 v[180:183], v[112:115], v[36:39], v[180:183]
    ds_read_b128 v[36:39], v247 offset:2112
    v_cvt_pk_bf16_f32 v11, v54, v55
    v_mfma_f32_16x16x32_bf16 v[176:179], v[84:87], v[40:43], v[176:179]
    v_mfma_f32_16x16x32_bf16 v[180:183], v[116:119], v[40:43], v[180:183]
    ds_read_b128 v[40:43], v247 offset:2048
    v_mfma_f32_16x16x32_bf16 v[184:187], v[240:243], v[124:127], v[184:187]
    v_cvt_pk_bf16_f32 v6, v172, v173
    v_mfma_f32_16x16x32_bf16 v[188:191], v[240:243], v[128:131], v[188:191]
    v_cvt_pk_bf16_f32 v7, v174, v175
    v_mfma_f32_16x16x32_bf16 v[192:195], v[240:243], v[132:135], v[192:195]
    buffer_store_dwordx2 v[6:7], v1, s[56:59], s9 offen offset:1024 sc1
    v_mfma_f32_16x16x32_bf16 v[184:187], v[248:251], v[136:139], v[184:187]
    v_mfma_f32_16x16x32_bf16 v[188:191], v[248:251], v[140:143], v[188:191]
    v_mfma_f32_16x16x32_bf16 v[192:195], v[248:251], v[144:147], v[192:195]
    v_mfma_f32_16x16x32_bf16 v[192:195], v[8:11], v[148:151], v[192:195]
    s_barrier
    s_waitcnt lgkmcnt(0)
    v_mfma_f32_16x16x32_bf16 v[196:199], v[12:15], v[212:215], 0
    v_mfma_f32_16x16x32_bf16 v[200:203], v[12:15], v[216:219], 0
    v_mfma_f32_16x16x32_bf16 v[204:207], v[12:15], v[220:223], 0
    v_mfma_f32_16x16x32_bf16 v[208:211], v[44:47], v[224:227], 0
    v_mfma_f32_16x16x32_bf16 v[188:191], v[120:123], v[12:15], v[188:191]
    v_mfma_f32_16x16x32_bf16 v[180:183], v[56:59], v[12:15], v[180:183]
    v_mfma_f32_16x16x32_bf16 v[184:187], v[88:91], v[12:15], v[184:187]
    ds_read_b128 v[12:15], v247 offset:3008
    ds_read_b128 v[44:47], v247 offset:2992
    v_mfma_f32_16x16x32_bf16 v[180:183], v[60:63], v[16:19], v[180:183]
    v_cvt_pk_bf16_f32 v240, v196, v197
    v_mfma_f32_16x16x32_bf16 v[184:187], v[92:95], v[16:19], v[184:187]
    ds_read_b128 v[16:19], v247 offset:2944
    v_cvt_pk_bf16_f32 v241, v198, v199
    v_mfma_f32_16x16x32_bf16 v[180:183], v[64:67], v[20:23], v[180:183]
    v_cvt_pk_bf16_f32 v242, v200, v201
    v_mfma_f32_16x16x32_bf16 v[184:187], v[96:99], v[20:23], v[184:187]
    ds_read_b128 v[20:23], v247 offset:2880
    v_cvt_pk_bf16_f32 v243, v202, v203
    v_mfma_f32_16x16x32_bf16 v[180:183], v[68:71], v[24:27], v[180:183]
    v_cvt_pk_bf16_f32 v248, v204, v205
    v_mfma_f32_16x16x32_bf16 v[184:187], v[100:103], v[24:27], v[184:187]
    ds_read_b128 v[24:27], v247 offset:2816
    v_cvt_pk_bf16_f32 v249, v206, v207
    v_mfma_f32_16x16x32_bf16 v[180:183], v[72:75], v[28:31], v[180:183]
    v_cvt_pk_bf16_f32 v250, v208, v209
    v_mfma_f32_16x16x32_bf16 v[184:187], v[104:107], v[28:31], v[184:187]
    ds_read_b128 v[28:31], v247 offset:2752
    v_cvt_pk_bf16_f32 v251, v210, v211
    v_mfma_f32_16x16x32_bf16 v[180:183], v[76:79], v[32:35], v[180:183]
    v_mfma_f32_16x16x32_bf16 v[184:187], v[108:111], v[32:35], v[184:187]
    ds_read_b128 v[32:35], v247 offset:2688
    v_mfma_f32_16x16x32_bf16 v[180:183], v[80:83], v[36:39], v[180:183]
    v_mfma_f32_16x16x32_bf16 v[184:187], v[112:115], v[36:39], v[184:187]
    ds_read_b128 v[36:39], v247 offset:2624
    v_mfma_f32_16x16x32_bf16 v[180:183], v[84:87], v[40:43], v[180:183]
    v_mfma_f32_16x16x32_bf16 v[184:187], v[116:119], v[40:43], v[184:187]
    ds_read_b128 v[40:43], v247 offset:2560
    v_mfma_f32_16x16x32_bf16 v[188:191], v[240:243], v[124:127], v[188:191]
    v_cvt_pk_bf16_f32 v6, v176, v177
    v_mfma_f32_16x16x32_bf16 v[192:195], v[240:243], v[128:131], v[192:195]
    v_cvt_pk_bf16_f32 v7, v178, v179
    v_mfma_f32_16x16x32_bf16 v[188:191], v[248:251], v[136:139], v[188:191]
    buffer_store_dwordx2 v[6:7], v1, s[56:59], s9 offen offset:1536 sc1
    v_mfma_f32_16x16x32_bf16 v[192:195], v[248:251], v[140:143], v[192:195]
    s_barrier
    s_waitcnt lgkmcnt(7)
    v_mfma_f32_16x16x32_bf16 v[196:199], v[12:15], v[212:215], 0
    v_mfma_f32_16x16x32_bf16 v[200:203], v[12:15], v[216:219], 0
    v_mfma_f32_16x16x32_bf16 v[204:207], v[12:15], v[220:223], 0
    v_mfma_f32_16x16x32_bf16 v[208:211], v[44:47], v[224:227], 0
    v_mfma_f32_16x16x32_bf16 v[192:195], v[120:123], v[12:15], v[192:195]
    v_mfma_f32_16x16x32_bf16 v[184:187], v[56:59], v[12:15], v[184:187]
    v_mfma_f32_16x16x32_bf16 v[188:191], v[88:91], v[12:15], v[188:191]
    ds_read_b128 v[12:15], v247 offset:3520
    s_waitcnt lgkmcnt(7)
    v_mfma_f32_16x16x32_bf16 v[184:187], v[60:63], v[16:19], v[184:187]
    v_cvt_pk_bf16_f32 v240, v196, v197
    v_mfma_f32_16x16x32_bf16 v[188:191], v[92:95], v[16:19], v[188:191]
    ds_read_b128 v[16:19], v247 offset:3456
    v_cvt_pk_bf16_f32 v241, v198, v199
    s_waitcnt lgkmcnt(7)
    v_mfma_f32_16x16x32_bf16 v[184:187], v[64:67], v[20:23], v[184:187]
    v_cvt_pk_bf16_f32 v242, v200, v201
    v_mfma_f32_16x16x32_bf16 v[188:191], v[96:99], v[20:23], v[188:191]
    ds_read_b128 v[20:23], v247 offset:3392
    v_cvt_pk_bf16_f32 v243, v202, v203
    s_waitcnt lgkmcnt(7)
    v_mfma_f32_16x16x32_bf16 v[184:187], v[68:71], v[24:27], v[184:187]
    v_cvt_pk_bf16_f32 v248, v204, v205
    v_mfma_f32_16x16x32_bf16 v[188:191], v[100:103], v[24:27], v[188:191]
    ds_read_b128 v[24:27], v247 offset:3328
    v_cvt_pk_bf16_f32 v249, v206, v207
    s_waitcnt lgkmcnt(7)
    v_mfma_f32_16x16x32_bf16 v[184:187], v[72:75], v[28:31], v[184:187]
    v_cvt_pk_bf16_f32 v250, v208, v209
    v_mfma_f32_16x16x32_bf16 v[188:191], v[104:107], v[28:31], v[188:191]
    ds_read_b128 v[28:31], v247 offset:3264
    v_cvt_pk_bf16_f32 v251, v210, v211
    s_waitcnt lgkmcnt(7)
    v_mfma_f32_16x16x32_bf16 v[184:187], v[76:79], v[32:35], v[184:187]
    v_mfma_f32_16x16x32_bf16 v[188:191], v[108:111], v[32:35], v[188:191]
    ds_read_b128 v[32:35], v247 offset:3200
    s_waitcnt lgkmcnt(7)
    v_mfma_f32_16x16x32_bf16 v[184:187], v[80:83], v[36:39], v[184:187]
    v_mfma_f32_16x16x32_bf16 v[188:191], v[112:115], v[36:39], v[188:191]
    ds_read_b128 v[36:39], v247 offset:3136
    s_waitcnt lgkmcnt(7)
    v_mfma_f32_16x16x32_bf16 v[184:187], v[84:87], v[40:43], v[184:187]
    v_mfma_f32_16x16x32_bf16 v[188:191], v[116:119], v[40:43], v[188:191]
    ds_read_b128 v[40:43], v247 offset:3072
    v_mfma_f32_16x16x32_bf16 v[192:195], v[240:243], v[124:127], v[192:195]
    v_cvt_pk_bf16_f32 v6, v180, v181
    v_mfma_f32_16x16x32_bf16 v[192:195], v[248:251], v[136:139], v[192:195]
    v_cvt_pk_bf16_f32 v7, v182, v183
    buffer_store_dwordx2 v[6:7], v1, s[56:59], s9 offen offset:2048 sc1
    s_barrier
    s_waitcnt lgkmcnt(7)
    v_mfma_f32_16x16x32_bf16 v[188:191], v[56:59], v[12:15], v[188:191]
    v_mfma_f32_16x16x32_bf16 v[192:195], v[88:91], v[12:15], v[192:195]
    ds_read_b128 v[12:15], v247 offset:4032
    s_waitcnt lgkmcnt(7)
    v_mfma_f32_16x16x32_bf16 v[188:191], v[60:63], v[16:19], v[188:191]
    v_mfma_f32_16x16x32_bf16 v[192:195], v[92:95], v[16:19], v[192:195]
    ds_read_b128 v[16:19], v247 offset:3968
    s_waitcnt lgkmcnt(7)
    v_mfma_f32_16x16x32_bf16 v[188:191], v[64:67], v[20:23], v[188:191]
    v_mfma_f32_16x16x32_bf16 v[192:195], v[96:99], v[20:23], v[192:195]
    ds_read_b128 v[20:23], v247 offset:3904
    s_waitcnt lgkmcnt(7)
    v_mfma_f32_16x16x32_bf16 v[188:191], v[68:71], v[24:27], v[188:191]
    v_mfma_f32_16x16x32_bf16 v[192:195], v[100:103], v[24:27], v[192:195]
    ds_read_b128 v[24:27], v247 offset:3840
    v_cvt_pk_bf16_f32 v6, v184, v185
    v_cvt_pk_bf16_f32 v7, v186, v187
    buffer_store_dwordx2 v[6:7], v1, s[56:59], s9 offen offset:2560 sc1
    s_waitcnt lgkmcnt(7)
    v_mfma_f32_16x16x32_bf16 v[188:191], v[72:75], v[28:31], v[188:191]
    v_mfma_f32_16x16x32_bf16 v[192:195], v[104:107], v[28:31], v[192:195]
    ds_read_b128 v[28:31], v247 offset:3776
    s_waitcnt lgkmcnt(7)
    v_mfma_f32_16x16x32_bf16 v[188:191], v[76:79], v[32:35], v[188:191]
    v_mfma_f32_16x16x32_bf16 v[192:195], v[108:111], v[32:35], v[192:195]
    ds_read_b128 v[32:35], v247 offset:3712
    s_waitcnt lgkmcnt(7)
    v_mfma_f32_16x16x32_bf16 v[188:191], v[80:83], v[36:39], v[188:191]
    v_mfma_f32_16x16x32_bf16 v[192:195], v[112:115], v[36:39], v[192:195]
    ds_read_b128 v[36:39], v247 offset:3648
    s_waitcnt lgkmcnt(7)
    v_mfma_f32_16x16x32_bf16 v[188:191], v[84:87], v[40:43], v[188:191]
    v_mfma_f32_16x16x32_bf16 v[192:195], v[116:119], v[40:43], v[192:195]
    ds_read_b128 v[40:43], v247 offset:3584
    s_waitcnt lgkmcnt(7)
    v_mfma_f32_16x16x32_bf16 v[192:195], v[56:59], v[12:15], v[192:195]
    s_waitcnt lgkmcnt(6)
    v_mfma_f32_16x16x32_bf16 v[192:195], v[60:63], v[16:19], v[192:195]
    s_waitcnt lgkmcnt(5)
    v_mfma_f32_16x16x32_bf16 v[192:195], v[64:67], v[20:23], v[192:195]
    s_waitcnt lgkmcnt(4)
    v_mfma_f32_16x16x32_bf16 v[192:195], v[68:71], v[24:27], v[192:195]
    v_cvt_pk_bf16_f32 v6, v188, v189
    v_cvt_pk_bf16_f32 v7, v190, v191
    buffer_store_dwordx2 v[6:7], v1, s[56:59], s9 offen offset:3072 sc1
    s_waitcnt lgkmcnt(3)
    v_mfma_f32_16x16x32_bf16 v[192:195], v[72:75], v[28:31], v[192:195]
    s_waitcnt lgkmcnt(2)
    v_mfma_f32_16x16x32_bf16 v[192:195], v[76:79], v[32:35], v[192:195]
    s_waitcnt lgkmcnt(1)
    v_mfma_f32_16x16x32_bf16 v[192:195], v[80:83], v[36:39], v[192:195]
    s_waitcnt lgkmcnt(0)
    v_mfma_f32_16x16x32_bf16 v[192:195], v[84:87], v[40:43], v[192:195]
    s_nop 7
    v_cvt_pk_bf16_f32 v6, v192, v193
    v_cvt_pk_bf16_f32 v7, v194, v195
    buffer_store_dwordx2 v[6:7], v1, s[56:59], s9 offen offset:3584 sc1
    s_branch K_SYNC
K1_GEMM:
    s_and_b32 s8, s3, 1
    s_lshr_b32 s9, s3, 1
    v_and_b32 v1, 31, v0
    v_lshrrev_b32 v2, 5, v0
    v_bfe_u32 v3, v0, 1, 3
    v_xor_b32 v3, v3, v2
    s_lshl_b32 s60, s8, 6
    v_add_u32 v1, s60, v1
    v_lshlrev_b32 v1, 7, v1
    v_xor_b32 v4, 0, v3
    v_lshl_add_u32 v4, v4, 4, v1
    v_xor_b32 v5, 2, v3
    v_lshl_add_u32 v5, v5, 4, v1
    v_xor_b32 v6, 4, v3
    v_lshl_add_u32 v6, v6, 4, v1
    v_xor_b32 v7, 6, v3
    v_lshl_add_u32 v7, v7, 4, v1
    v_bfe_u32 v1, v0, 2, 2
    v_lshlrev_b32 v8, 7, v1
    v_bfe_u32 v1, v0, 4, 1
    v_lshlrev_b32 v1, 5, v1
    v_and_b32 v3, 3, v0
    v_lshl_add_u32 v1, v3, 3, v1
    s_lshl_b32 s60, s9, 6
    v_add_u32 v1, s60, v1
    v_bfe_u32 v3, v0, 3, 1
    v_lshlrev_b32 v3, 6, v3
    v_xor_b32 v1, v1, v3
    v_add_u32 v8, v8, v1
    v_add_u32 v8, 131072, v8
    v_lshl_add_u32 v13, v2, 11, v8
    v_mov_b64 v[96:97], 0
    v_mov_b64 v[98:99], 0
    v_mov_b64 v[100:101], 0
    v_mov_b64 v[102:103], 0
    v_mov_b64 v[104:105], 0
    v_mov_b64 v[106:107], 0
    v_mov_b64 v[108:109], 0
    v_mov_b64 v[110:111], 0
    v_mov_b64 v[112:113], 0
    v_mov_b64 v[114:115], 0
    v_mov_b64 v[116:117], 0
    v_mov_b64 v[118:119], 0
    v_mov_b64 v[120:121], 0
    v_mov_b64 v[122:123], 0
    v_mov_b64 v[124:125], 0
    v_mov_b64 v[126:127], 0
    v_mov_b64 v[128:129], 0
    v_mov_b64 v[130:131], 0
    v_mov_b64 v[132:133], 0
    v_mov_b64 v[134:135], 0
    v_mov_b64 v[136:137], 0
    v_mov_b64 v[138:139], 0
    v_mov_b64 v[140:141], 0
    v_mov_b64 v[142:143], 0
    v_mov_b64 v[144:145], 0
    v_mov_b64 v[146:147], 0
    v_mov_b64 v[148:149], 0
    v_mov_b64 v[150:151], 0
    v_mov_b64 v[152:153], 0
    v_mov_b64 v[154:155], 0
    v_mov_b64 v[156:157], 0
    v_mov_b64 v[158:159], 0
    s_lshl_b32 s14, s7, 2
    s_lshl_b32 s13, s9, 1
    s_add_u32 s14, s14, s13
    v_bfe_u32 v14, v0, 4, 1
    v_add_u32 v14, s14, v14
    v_mul_u32_u24 v14, 2048, v14
    v_and_b32 v1, 3, v0
    v_bfe_u32 v3, v0, 2, 1
    v_lshl_add_u32 v1, v3, 3, v1
    v_bfe_u32 v3, v0, 3, 1
    v_lshl_add_u32 v1, v3, 2, v1
    v_lshl_add_u32 v14, v1, 2, v14
    v_add_u32 v14, 0x400000, v14
    v_lshl_add_u32 v15, v2, 8, v14
    s_lshl_b32 s13, s8, 9
    v_add_u32 v15, s13, v15
    v_lshlrev_b32 v56, 4, v0
    s_mul_i32 s13, s3, 1280
    v_add_u32 v58, s13, v56
    s_xor_b32 s15, s3, 1
    s_mul_i32 s15, s15, 1280
    v_add_u32 v59, s15, v56
    v_lshlrev_b32 v1, 2, v0
    v_add_u32 v60, s13, v1
    v_add_u32 v61, s15, v1
    s_mov_b32 s10, 0x3fb8aa3b
    s_mov_b32 s11, 0x3fb8aa3b
    s_mov_b32 s12, 0x358637bd
    s_mov_b32 s14, 0xffff0000
    s_mov_b32 s15, 0xffff0000
    s_cmp_eq_u32 s8, 0
    s_cselect_b64 s[80:81], 0, -1
    s_cselect_b32 s82, -1, 0
    s_lshl_b32 s83, s3, 10
    v_mov_b32 v232, 0x3f803f80
    v_mov_b32 v233, 0x3f803f80
    v_mov_b32 v234, 0x3f803f80
    v_mov_b32 v235, 0x3f803f80
    s_waitcnt lgkmcnt(0)
    s_mov_b32 s56, s46
    s_mov_b32 s57, s47
    s_mov_b32 s58, 0x600000
    s_mov_b32 s59, 0x20000
    s_mov_b32 s4, 0
    s_barrier
    ds_read_b128 v[16:19], v4
    ds_read_b64_tr_b16 v[24:25], v13 offset:0
    ds_read_b64_tr_b16 v[26:27], v13 offset:512
    ds_read_b128 v[20:23], v4 offset:4096
    ds_read_b64_tr_b16 v[28:29], v13 offset:1024
    ds_read_b64_tr_b16 v[30:31], v13 offset:1536
K1_G_LOOP:
    s_waitcnt lgkmcnt(0)
    v_mfma_f32_32x32x16_bf16 v[96:111], v[16:19], v[24:27], v[96:111]
    ds_read_b128 v[32:35], v5
    ds_read_b64_tr_b16 v[40:41], v13 offset:4096
    ds_read_b64_tr_b16 v[42:43], v13 offset:4608
    v_mfma_f32_32x32x16_bf16 v[112:127], v[20:23], v[24:27], v[112:127]
    ds_read_b128 v[36:39], v5 offset:4096
    ds_read_b64_tr_b16 v[44:45], v13 offset:5120
    ds_read_b64_tr_b16 v[46:47], v13 offset:5632
    v_mfma_f32_32x32x16_bf16 v[128:143], v[16:19], v[28:31], v[128:143]
    v_mfma_f32_32x32x16_bf16 v[144:159], v[20:23], v[28:31], v[144:159]
    s_waitcnt lgkmcnt(0)
    s_barrier
    v_mfma_f32_32x32x16_bf16 v[96:111], v[32:35], v[40:43], v[96:111]
    ds_read_b128 v[16:19], v6
    ds_read_b64_tr_b16 v[24:25], v13 offset:8192
    ds_read_b64_tr_b16 v[26:27], v13 offset:8704
    v_mfma_f32_32x32x16_bf16 v[112:127], v[36:39], v[40:43], v[112:127]
    ds_read_b128 v[20:23], v6 offset:4096
    ds_read_b64_tr_b16 v[28:29], v13 offset:9216
    ds_read_b64_tr_b16 v[30:31], v13 offset:9728
    v_mfma_f32_32x32x16_bf16 v[128:143], v[32:35], v[44:47], v[128:143]
    v_mfma_f32_32x32x16_bf16 v[144:159], v[36:39], v[44:47], v[144:159]
    s_waitcnt lgkmcnt(0)
    v_mfma_f32_32x32x16_bf16 v[96:111], v[16:19], v[24:27], v[96:111]
    ds_read_b128 v[32:35], v7
    ds_read_b64_tr_b16 v[40:41], v13 offset:12288
    ds_read_b64_tr_b16 v[42:43], v13 offset:12800
    v_mfma_f32_32x32x16_bf16 v[112:127], v[20:23], v[24:27], v[112:127]
    ds_read_b128 v[36:39], v7 offset:4096
    ds_read_b64_tr_b16 v[44:45], v13 offset:13312
    ds_read_b64_tr_b16 v[46:47], v13 offset:13824
    v_mfma_f32_32x32x16_bf16 v[128:143], v[16:19], v[28:31], v[128:143]
    v_add_u32 v4, 16384, v4
    v_add_u32 v5, 16384, v5
    v_add_u32 v6, 16384, v6
    v_add_u32 v7, 16384, v7
    v_xor_b32 v13, 16384, v13
    s_add_u32 s4, s4, 1
    s_cmp_lt_u32 s4, 8
    v_mfma_f32_32x32x16_bf16 v[144:159], v[20:23], v[28:31], v[144:159]
    s_waitcnt lgkmcnt(0)
    s_barrier
    s_cbranch_scc0 K1_G_TAIL
    v_mfma_f32_32x32x16_bf16 v[96:111], v[32:35], v[40:43], v[96:111]
    ds_read_b128 v[16:19], v4
    ds_read_b64_tr_b16 v[24:25], v13 offset:0
    ds_read_b64_tr_b16 v[26:27], v13 offset:512
    v_mfma_f32_32x32x16_bf16 v[112:127], v[36:39], v[40:43], v[112:127]
    ds_read_b128 v[20:23], v4 offset:4096
    ds_read_b64_tr_b16 v[28:29], v13 offset:1024
    ds_read_b64_tr_b16 v[30:31], v13 offset:1536
    v_mfma_f32_32x32x16_bf16 v[128:143], v[32:35], v[44:47], v[128:143]
    v_mfma_f32_32x32x16_bf16 v[144:159], v[36:39], v[44:47], v[144:159]
    s_branch K1_G_LOOP
K1_G_TAIL:
    v_mfma_f32_32x32x16_bf16 v[96:111], v[32:35], v[40:43], v[96:111]
    v_mfma_f32_32x32x16_bf16 v[112:127], v[36:39], v[40:43], v[112:127]
    v_mfma_f32_32x32x16_bf16 v[128:143], v[32:35], v[44:47], v[128:143]
    v_mfma_f32_32x32x16_bf16 v[144:159], v[36:39], v[44:47], v[144:159]
    s_barrier
    s_load_dwordx8 s[84:91], s[44:45], 0
    s_nop 6
    v_mul_f32 v208, s10, v96
    v_mul_f32 v209, s10, v97
    v_mul_f32 v210, s10, v98
    v_mul_f32 v211, s10, v99
    v_mul_f32 v212, s10, v100
    v_mul_f32 v213, s10, v101
    v_mul_f32 v214, s10, v102
    v_mul_f32 v215, s10, v103
    v_exp_f32_e64 v208, v208 clamp
    v_max_f32 v96, s12, v96
    v_exp_f32_e64 v209, v209 clamp
    v_max_f32 v97, s12, v97
    v_exp_f32_e64 v210, v210 clamp
    v_max_f32 v98, s12, v98
    v_exp_f32_e64 v211, v211 clamp
    v_max_f32 v99, s12, v99
    v_exp_f32_e64 v212, v212 clamp
    v_max_f32 v100, s12, v100
    v_exp_f32_e64 v213, v213 clamp
    v_max_f32 v101, s12, v101
    v_exp_f32_e64 v214, v214 clamp
    v_max_f32 v102, s12, v102
    v_exp_f32_e64 v215, v215 clamp
    v_max_f32 v103, s12, v103
    v_add_f32 v96, v96, v208
    v_add_f32 v97, v97, v209
    v_add_f32 v98, v98, v210
    v_add_f32 v99, v99, v211
    v_add_f32 v100, v100, v212
    v_add_f32 v101, v101, v213
    v_add_f32 v102, v102, v214
    v_add_f32 v103, v103, v215
    v_cvt_pk_bf16_f32 v16, v96, v97
    v_cvt_pk_bf16_f32 v17, v98, v99
    v_cvt_pk_bf16_f32 v18, v100, v101
    v_cvt_pk_bf16_f32 v19, v102, v103
    v_mul_f32 v216, s10, v104
    v_mul_f32 v217, s10, v105
    v_mul_f32 v218, s10, v106
    v_mul_f32 v219, s10, v107
    v_mul_f32 v220, s10, v108
    s_barrier
    v_mul_f32 v221, s10, v109
    v_mul_f32 v222, s10, v110
    v_mul_f32 v223, s10, v111
    v_exp_f32_e64 v216, v216 clamp
    v_max_f32 v104, s12, v104
    v_exp_f32_e64 v217, v217 clamp
    v_max_f32 v105, s12, v105
    v_exp_f32_e64 v218, v218 clamp
    v_max_f32 v106, s12, v106
    v_exp_f32_e64 v219, v219 clamp
    v_max_f32 v107, s12, v107
    v_exp_f32_e64 v220, v220 clamp
    v_max_f32 v108, s12, v108
    v_exp_f32_e64 v221, v221 clamp
    v_max_f32 v109, s12, v109
    v_exp_f32_e64 v222, v222 clamp
    v_max_f32 v110, s12, v110
    v_exp_f32_e64 v223, v223 clamp
    v_max_f32 v111, s12, v111
    v_add_f32 v104, v104, v216
    v_add_f32 v105, v105, v217
    v_add_f32 v106, v106, v218
    v_add_f32 v107, v107, v219
    v_add_f32 v108, v108, v220
    v_add_f32 v109, v109, v221
    v_add_f32 v110, v110, v222
    v_add_f32 v111, v111, v223
    v_cvt_pk_bf16_f32 v20, v104, v105
    v_cvt_pk_bf16_f32 v21, v106, v107
    v_cvt_pk_bf16_f32 v22, v108, v109
    v_cvt_pk_bf16_f32 v23, v110, v111
    v_mul_f32 v208, s10, v112
    v_mul_f32 v209, s10, v113
    v_mul_f32 v210, s10, v114
    v_mul_f32 v211, s10, v115
    v_mul_f32 v212, s10, v116
    v_mul_f32 v213, s10, v117
    v_mul_f32 v214, s10, v118
    v_mul_f32 v215, s10, v119
    v_exp_f32_e64 v208, v208 clamp
    s_barrier
    v_max_f32 v112, s12, v112
    v_exp_f32_e64 v209, v209 clamp
    v_max_f32 v113, s12, v113
    v_exp_f32_e64 v210, v210 clamp
    v_max_f32 v114, s12, v114
    v_exp_f32_e64 v211, v211 clamp
    v_max_f32 v115, s12, v115
    v_exp_f32_e64 v212, v212 clamp
    v_max_f32 v116, s12, v116
    v_exp_f32_e64 v213, v213 clamp
    v_max_f32 v117, s12, v117
    v_exp_f32_e64 v214, v214 clamp
    v_max_f32 v118, s12, v118
    v_exp_f32_e64 v215, v215 clamp
    v_max_f32 v119, s12, v119
    v_add_f32 v112, v112, v208
    v_add_f32 v113, v113, v209
    v_add_f32 v114, v114, v210
    v_add_f32 v115, v115, v211
    v_add_f32 v116, v116, v212
    v_add_f32 v117, v117, v213
    v_add_f32 v118, v118, v214
    v_add_f32 v119, v119, v215
    v_cvt_pk_bf16_f32 v24, v112, v113
    v_cvt_pk_bf16_f32 v25, v114, v115
    v_cvt_pk_bf16_f32 v26, v116, v117
    v_cvt_pk_bf16_f32 v27, v118, v119
    v_mul_f32 v216, s10, v120
    v_mul_f32 v217, s10, v121
    v_mul_f32 v218, s10, v122
    v_mul_f32 v219, s10, v123
    v_mul_f32 v220, s10, v124
    v_mul_f32 v221, s10, v125
    v_mul_f32 v222, s10, v126
    v_mul_f32 v223, s10, v127
    v_exp_f32_e64 v216, v216 clamp
    v_max_f32 v120, s12, v120
    v_exp_f32_e64 v217, v217 clamp
    v_max_f32 v121, s12, v121
    v_exp_f32_e64 v218, v218 clamp
    s_barrier
    v_max_f32 v122, s12, v122
    v_exp_f32_e64 v219, v219 clamp
    v_max_f32 v123, s12, v123
    v_exp_f32_e64 v220, v220 clamp
    v_max_f32 v124, s12, v124
    v_exp_f32_e64 v221, v221 clamp
    v_max_f32 v125, s12, v125
    v_exp_f32_e64 v222, v222 clamp
    v_max_f32 v126, s12, v126
    v_exp_f32_e64 v223, v223 clamp
    v_max_f32 v127, s12, v127
    v_add_f32 v120, v120, v216
    v_add_f32 v121, v121, v217
    v_add_f32 v122, v122, v218
    v_add_f32 v123, v123, v219
    v_add_f32 v124, v124, v220
    v_add_f32 v125, v125, v221
    v_add_f32 v126, v126, v222
    v_add_f32 v127, v127, v223
    v_cvt_pk_bf16_f32 v28, v120, v121
    v_cvt_pk_bf16_f32 v29, v122, v123
    v_cvt_pk_bf16_f32 v30, v124, v125
    v_cvt_pk_bf16_f32 v31, v126, v127
    v_cvt_pk_bf16_f32 v128, v128, v129
    v_cvt_pk_bf16_f32 v129, v130, v131
    v_cvt_pk_bf16_f32 v130, v132, v133
    v_cvt_pk_bf16_f32 v131, v134, v135
    v_cvt_pk_bf16_f32 v132, v136, v137
    v_cvt_pk_bf16_f32 v133, v138, v139
    v_cvt_pk_bf16_f32 v134, v140, v141
    v_cvt_pk_bf16_f32 v135, v142, v143
    v_cvt_pk_bf16_f32 v144, v144, v145
    v_cvt_pk_bf16_f32 v145, v146, v147
    v_cvt_pk_bf16_f32 v146, v148, v149
    v_cvt_pk_bf16_f32 v147, v150, v151
    v_cvt_pk_bf16_f32 v148, v152, v153
    v_cvt_pk_bf16_f32 v149, v154, v155
    v_cvt_pk_bf16_f32 v150, v156, v157
    v_cvt_pk_bf16_f32 v151, v158, v159
    v_mfma_f32_32x32x16_bf16 v[96:111], v[128:131], v[16:19], 0
    v_mfma_f32_32x32x16_bf16 v[96:111], v[132:135], v[20:23], v[96:111]
    v_mfma_f32_32x32x16_bf16 v[96:111], v[144:147], v[24:27], v[96:111]
    v_mfma_f32_32x32x16_bf16 v[96:111], v[148:151], v[28:31], v[96:111]
    s_barrier
    v_mfma_f32_32x32x16_bf16 v[112:127], v[232:235], v[16:19], 0
    v_mfma_f32_32x32x16_bf16 v[112:127], v[232:235], v[20:23], v[112:127]
    v_mfma_f32_32x32x16_bf16 v[112:127], v[232:235], v[24:27], v[112:127]
    v_mfma_f32_32x32x16_bf16 v[112:127], v[232:235], v[28:31], v[112:127]
    s_nop 6
    v_cndmask_b32_e64 v96, v96, v104, s[14:15]
    v_cndmask_b32_e64 v97, v97, v105, s[14:15]
    v_cndmask_b32_e64 v98, v98, v106, s[14:15]
    v_cndmask_b32_e64 v99, v99, v107, s[14:15]
    v_cndmask_b32_e64 v100, v100, v108, s[14:15]
    v_cndmask_b32_e64 v101, v101, v109, s[14:15]
    v_cndmask_b32_e64 v102, v102, v110, s[14:15]
    v_cndmask_b32_e64 v103, v103, v111, s[14:15]
    v_cndmask_b32_e64 v40, v100, v96, s[80:81]
    v_cndmask_b32_e64 v41, v101, v97, s[80:81]
    v_cndmask_b32_e64 v42, v102, v98, s[80:81]
    v_cndmask_b32_e64 v43, v103, v99, s[80:81]
    ds_write_b128 v58, v[40:43]
    v_cndmask_b32_e64 v36, v96, v100, s[80:81]
    v_cndmask_b32_e64 v37, v97, v101, s[80:81]
    v_cndmask_b32_e64 v38, v98, v102, s[80:81]
    v_cndmask_b32_e64 v39, v99, v103, s[80:81]
    ds_write_b32 v60, v112 offset:1024
    s_waitcnt lgkmcnt(0)
    s_barrier
    ds_read_b128 v[40:43], v59
    ds_read_b32 v44, v61 offset:1024
    s_and_b64 s[84:85], s[84:85], s[86:87]
    s_and_b64 s[88:89], s[88:89], s[90:91]
    s_and_b64 s[84:85], s[84:85], s[88:89]
    s_and_b32 s84, s84, s85
    s_cbranch_scc1 INIT_OK_G
    v_and_b32 v62, 7, v0
    v_lshlrev_b32 v62, 2, v62
    s_mov_b32 s84, 0
INIT_POLL_G:
    global_load_dword v63, v62, s[44:45] sc1
    s_waitcnt vmcnt(0)
    v_cmp_eq_u32 vcc, 0, v63
    s_cbranch_vccz INIT_OK_G
    s_add_u32 s84, s84, 1
    s_cmp_gt_u32 s84, 0x40000
    s_cbranch_scc1 INIT_OK_G
    s_sleep 8
    s_branch INIT_POLL_G
INIT_OK_G:
    s_waitcnt lgkmcnt(0)
    v_add_f32 v36, v36, v40
    v_add_f32 v37, v37, v41
    v_add_f32 v38, v38, v42
    v_add_f32 v39, v39, v43
    v_add_f32 v44, v44, v112
    buffer_atomic_add_f32 v36, v15, s[56:59], 0 offen offset:0
    buffer_atomic_add_f32 v37, v15, s[56:59], 0 offen offset:64
    buffer_atomic_add_f32 v38, v15, s[56:59], 0 offen offset:128
    buffer_atomic_add_f32 v39, v15, s[56:59], 0 offen offset:192
    s_cmp_lg_u32 s8, 0
    s_cbranch_scc1 K1_NOZ
    s_mov_b32 exec_hi, 0
    buffer_atomic_add_f32 v44, v14, s[56:59], 0 offen offset:1024
    s_mov_b32 exec_hi, -1
K1_NOZ:
    s_barrier
K_SYNC:
    s_setprio 0
    s_waitcnt vmcnt(0) lgkmcnt(0)
    s_barrier
    s_cmp_lg_u32 s3, 4
    s_cbranch_scc1 K_NOARR
    v_lshlrev_b32 v1, 12, v0
    s_lshl_b32 s92, s92, 8
    s_add_u32 s92, s92, 0x420000
    v_mov_b32 v2, 1
    s_mov_b32 exec_hi, 0
    buffer_atomic_add v2, v1, s[56:59], s92 offen sc1
    s_mov_b32 exec_hi, -1
K_NOARR:
    s_and_b32 s4, s2, 7
    s_lshr_b32 s5, s2, 3
    s_and_b32 s6, s4, 3
    s_lshl_b32 s6, s6, 3
    s_lshr_b32 s7, s4, 2
    s_lshl_b32 s7, s7, 2
    s_add_u32 s6, s6, s7
    s_and_b32 s7, s5, 3
    s_add_u32 s6, s6, s7
    s_lshr_b32 s7, s5, 2
    s_and_b32 s8, s3, 1
    s_bfe_u32 s9, s3, 0x10001
    v_lshlrev_b32 v1, 4, v0
    v_lshrrev_b32 v6, 3, v0
    v_bfe_u32 v7, v0, 4, 1
    v_lshlrev_b32 v7, 2, v7
    v_and_b32 v8, 7, v0
    v_xor_b32 v7, v7, v8
    s_add_u32 s80, s7, 0
    s_and_b32 s80, s80, 7
    s_add_u32 s81, s7, 1
    s_and_b32 s81, s81, 7
    s_add_u32 s82, s7, 2
    s_and_b32 s82, s82, 7
    s_add_u32 s83, s7, 3
    s_and_b32 s83, s83, 7
    s_add_u32 s84, s7, 4
    s_and_b32 s84, s84, 7
    s_add_u32 s85, s7, 5
    s_and_b32 s85, s85, 7
    s_add_u32 s86, s7, 6
    s_and_b32 s86, s86, 7
    s_add_u32 s87, s7, 7
    s_and_b32 s87, s87, 7
    s_cmp_lt_u32 s3, 4
    s_cbranch_scc1 K2_COMPUTE
    s_lshl_b32 s13, s8, 5
    s_lshl_b32 s14, s9, 4
    s_add_u32 s13, s13, s14
    s_lshl_b32 s13, s13, 10
    s_lshl_b32 s10, s6, 16
    s_add_u32 s10, s10, s13
    v_add_u32 v11, s10, v1
    s_add_u32 s13, s13, 65536
    s_add_u32 s14, s14, s8
    s_mul_i32 s10, s14, 2048
    s_add_u32 s10, s10, 0x400000
    v_add_u32 v2, s10, v1
    v_bfe_u32 v3, v0, 2, 3
    v_add_u32 v4, s7, v3
    v_and_b32 v4, 7, v4
    v_mul_u32_u24 v4, 4096, v4
    v_and_b32 v5, 3, v0
    v_lshl_add_u32 v4, v5, 4, v4
    v_add_u32 v4, s10, v4
    s_sub_u32 s15, s3, 4
    s_lshl_b32 s10, s7, 6
    s_lshl_b32 s11, s15, 4
    s_add_u32 s10, s10, s11
    v_add_u32 v10, s10, v6
    v_lshlrev_b32 v10, 12, v10
    v_lshl_add_u32 v10, v7, 4, v10
    s_lshl_b32 s10, s6, 7
    s_add_u32 s10, s10, 0x200000
    v_add_u32 v10, s10, v10
    s_lshl_b32 s15, s15, 11
    s_add_u32 s15, s15, 149504
    s_mul_i32 s10, s14, 576
    s_add_u32 s10, s10, 131072
    v_lshlrev_b32 v12, 3, v0
    v_add_u32 v12, s10, v12
    v_mul_u32_u24 v13, 1152, v3
    v_xor_b32 v5, 2, v5
    v_lshl_add_u32 v13, v5, 3, v13
    v_add_u32 v13, s10, v13
    v_mov_b32 v14, v0
    s_add_u32 s10, s7, 8
    v_writelane_b32 v14, s10, 8
    s_add_u32 s10, s4, 8
    v_writelane_b32 v14, s10, 9
    v_lshlrev_b32 v14, 8, v14
    s_lshl_b32 s88, s5, 12
    s_add_u32 s88, s88, 0x420000
    s_mov_b32 s90, 0
    s_cmp_lg_u32 s3, 4
    s_cbranch_scc1 K_POLL_DONE_A
    s_and_b32 s89, s90, 255
    s_cmp_eq_u32 s89, 255
    s_cbranch_scc1 K_POLL_DONE_A
    s_mov_b32 s91, 0
    s_mov_b64 exec, 0x3ff
K_POLL_A:
    v_mov_b32 v15, 0
    buffer_atomic_add v15, v14, s[56:59], s88 offen sc0 sc1
    s_add_u32 s91, s91, 1
    s_waitcnt vmcnt(0)
    v_cmp_eq_u32 vcc, 16, v15
    s_mov_b32 s90, vcc_lo
    s_and_b32 s89, s90, 255
    s_cmp_eq_u32 s89, 255
    s_cbranch_scc1 K_POLL_EXIT_A
    s_cmp_lt_u32 s91, 0x40000
    s_cbranch_scc1 K_POLL_A
K_POLL_EXIT_A:
    s_mov_b64 exec, -1
K_POLL_DONE_A:
    s_barrier
    buffer_load_dwordx4 v[48:51], v4, s[56:59], 0 offen offset:1024 sc1
    s_mul_i32 s60, s80, 4096
    buffer_load_dwordx4 v[16:19], v2, s[56:59], s60 offen sc1
    s_add_u32 m0, s13, 0
    s_lshl_b32 s60, s80, 11
    buffer_load_dwordx4 v11, s[56:59], s60 offen offset:0 sc1 lds
    buffer_load_dwordx4 v11, s[56:59], s60 offen offset:1024 sc1 lds
    s_mul_i32 s60, s81, 4096
    buffer_load_dwordx4 v[20:23], v2, s[56:59], s60 offen sc1
    s_add_u32 m0, s13, 2048
    s_lshl_b32 s60, s81, 11
    buffer_load_dwordx4 v11, s[56:59], s60 offen offset:0 sc1 lds
    buffer_load_dwordx4 v11, s[56:59], s60 offen offset:1024 sc1 lds
    s_mul_i32 s60, s82, 4096
    buffer_load_dwordx4 v[24:27], v2, s[56:59], s60 offen sc1
    s_add_u32 m0, s13, 4096
    s_lshl_b32 s60, s82, 11
    buffer_load_dwordx4 v11, s[56:59], s60 offen offset:0 sc1 lds
    buffer_load_dwordx4 v11, s[56:59], s60 offen offset:1024 sc1 lds
    s_mul_i32 s60, s83, 4096
    buffer_load_dwordx4 v[28:31], v2, s[56:59], s60 offen sc1
    s_add_u32 m0, s13, 6144
    s_lshl_b32 s60, s83, 11
    buffer_load_dwordx4 v11, s[56:59], s60 offen offset:0 sc1 lds
    buffer_load_dwordx4 v11, s[56:59], s60 offen offset:1024 sc1 lds
    s_waitcnt vmcnt(9)
    v_cvt_pk_bf16_f32 v48, v48, v49
    v_cvt_pk_bf16_f32 v49, v50, v51
    s_mov_b32 exec_hi, 0
    ds_write_b64 v13, v[48:49] offset:512
    s_mov_b32 exec_hi, -1
    v_cvt_pk_bf16_f32 v16, v16, v17
    v_cvt_pk_bf16_f32 v17, v18, v19
    ds_write_b64 v12, v[16:17] offset:0
    s_waitcnt lgkmcnt(0)
    s_barrier
    s_mul_i32 s60, s84, 4096
    buffer_load_dwordx4 v[32:35], v2, s[56:59], s60 offen sc1
    s_add_u32 m0, s13, 8192
    s_lshl_b32 s60, s84, 11
    buffer_load_dwordx4 v11, s[56:59], s60 offen offset:0 sc1 lds
    buffer_load_dwordx4 v11, s[56:59], s60 offen offset:1024 sc1 lds
    s_waitcnt vmcnt(9)
    v_cvt_pk_bf16_f32 v20, v20, v21
    v_cvt_pk_bf16_f32 v21, v22, v23
    ds_write_b64 v12, v[20:21] offset:1152
    s_waitcnt lgkmcnt(0)
    s_barrier
    s_mul_i32 s60, s85, 4096
    buffer_load_dwordx4 v[36:39], v2, s[56:59], s60 offen sc1
    s_add_u32 m0, s13, 10240
    s_lshl_b32 s60, s85, 11
    buffer_load_dwordx4 v11, s[56:59], s60 offen offset:0 sc1 lds
    buffer_load_dwordx4 v11, s[56:59], s60 offen offset:1024 sc1 lds
    s_waitcnt vmcnt(9)
    v_cvt_pk_bf16_f32 v24, v24, v25
    v_cvt_pk_bf16_f32 v25, v26, v27
    ds_write_b64 v12, v[24:25] offset:2304
    s_waitcnt lgkmcnt(0)
    s_barrier
    s_mul_i32 s60, s86, 4096
    buffer_load_dwordx4 v[40:43], v2, s[56:59], s60 offen sc1
    s_add_u32 m0, s13, 12288
    s_lshl_b32 s60, s86, 11
    buffer_load_dwordx4 v11, s[56:59], s60 offen offset:0 sc1 lds
    buffer_load_dwordx4 v11, s[56:59], s60 offen offset:1024 sc1 lds
    s_waitcnt vmcnt(9)
    v_cvt_pk_bf16_f32 v28, v28, v29
    v_cvt_pk_bf16_f32 v29, v30, v31
    ds_write_b64 v12, v[28:29] offset:3456
    s_waitcnt lgkmcnt(0)
    s_barrier
    s_mul_i32 s60, s87, 4096
    buffer_load_dwordx4 v[44:47], v2, s[56:59], s60 offen sc1
    s_add_u32 m0, s13, 14336
    s_lshl_b32 s60, s87, 11
    buffer_load_dwordx4 v11, s[56:59], s60 offen offset:0 sc1 lds
    buffer_load_dwordx4 v11, s[56:59], s60 offen offset:1024 sc1 lds
    s_waitcnt vmcnt(9)
    v_cvt_pk_bf16_f32 v32, v32, v33
    v_cvt_pk_bf16_f32 v33, v34, v35
    ds_write_b64 v12, v[32:33] offset:4608
    s_waitcnt lgkmcnt(0)
    s_barrier
    s_waitcnt vmcnt(6)
    v_cvt_pk_bf16_f32 v36, v36, v37
    v_cvt_pk_bf16_f32 v37, v38, v39
    ds_write_b64 v12, v[36:37] offset:5760
    s_waitcnt lgkmcnt(0)
    s_cmp_lg_u32 s3, 4
    s_cbranch_scc1 K_POLL_DONE_B
    s_and_b32 s89, s90, 768
    s_cmp_eq_u32 s89, 768
    s_cbranch_scc1 K_POLL_DONE_B
    s_mov_b32 s91, 0
    s_mov_b64 exec, 0x3ff
K_POLL_B:
    v_mov_b32 v15, 0
    buffer_atomic_add v15, v14, s[56:59], s88 offen sc0 sc1
    s_add_u32 s91, s91, 1
    s_waitcnt vmcnt(0)
    v_cmp_eq_u32 vcc, 16, v15
    s_mov_b32 s90, vcc_lo
    s_and_b32 s89, s90, 768
    s_cmp_eq_u32 s89, 768
    s_cbranch_scc1 K_POLL_EXIT_B
    s_cmp_lt_u32 s91, 0x40000
    s_cbranch_scc1 K_POLL_B
K_POLL_EXIT_B:
    s_mov_b64 exec, -1
K_POLL_DONE_B:
    s_barrier
    s_add_u32 m0, s15, 0
    s_mov_b32 s60, 0
    buffer_load_dwordx4 v10, s[56:59], s60 offen sc1 lds
    s_add_u32 m0, s15, 1024
    s_mov_b32 s60, 32768
    buffer_load_dwordx4 v10, s[56:59], s60 offen sc1 lds
    s_waitcnt vmcnt(5)
    v_cvt_pk_bf16_f32 v40, v40, v41
    v_cvt_pk_bf16_f32 v41, v42, v43
    ds_write_b64 v12, v[40:41] offset:6912
    s_waitcnt lgkmcnt(0)
    s_barrier
    s_waitcnt vmcnt(2)
    v_cvt_pk_bf16_f32 v44, v44, v45
    v_cvt_pk_bf16_f32 v45, v46, v47
    ds_write_b64 v12, v[44:45] offset:8064
    s_waitcnt lgkmcnt(0)
    s_barrier
    s_waitcnt vmcnt(0)
    s_barrier
    s_endpgm
K2_COMPUTE:
    s_lshl_b32 s12, s9, 8
    s_lshl_b32 s13, s8, 4
    s_add_u32 s12, s12, s13
    v_add_u32 v9, s12, v6
    v_lshlrev_b32 v9, 10, v9
    v_lshl_add_u32 v9, v7, 4, v9
    s_lshl_b32 s13, s7, 7
    v_add_u32 v9, s13, v9
    s_lshl_b32 s12, s12, 7
    s_mov_b32 s48, s20
    s_mov_b32 s49, s21
    s_mov_b32 s50, 0x80000
    s_mov_b32 s51, 0x20000
    s_lshl_b32 s61, s80, 15
    s_add_u32 m0, s12, 0
    s_add_u32 s60, s61, 0
    buffer_load_dwordx4 v9, s[48:51], s60 offen lds
    s_add_u32 m0, s12, 1024
    s_add_u32 s60, s61, 8192
    buffer_load_dwordx4 v9, s[48:51], s60 offen lds
    s_lshl_b32 s61, s81, 15
    s_add_u32 m0, s12, 4096
    s_add_u32 s60, s61, 0
    buffer_load_dwordx4 v9, s[48:51], s60 offen lds
    s_add_u32 m0, s12, 5120
    s_add_u32 s60, s61, 8192
    buffer_load_dwordx4 v9, s[48:51], s60 offen lds
    s_lshl_b32 s61, s82, 15
    s_add_u32 m0, s12, 8192
    s_add_u32 s60, s61, 0
    buffer_load_dwordx4 v9, s[48:51], s60 offen lds
    s_add_u32 m0, s12, 9216
    s_add_u32 s60, s61, 8192
    buffer_load_dwordx4 v9, s[48:51], s60 offen lds
    s_lshl_b32 s61, s83, 15
    s_add_u32 m0, s12, 12288
    s_add_u32 s60, s61, 0
    buffer_load_dwordx4 v9, s[48:51], s60 offen lds
    s_add_u32 m0, s12, 13312
    s_add_u32 s60, s61, 8192
    buffer_load_dwordx4 v9, s[48:51], s60 offen lds
    s_lshl_b32 s61, s84, 15
    s_add_u32 m0, s12, 16384
    s_add_u32 s60, s61, 0
    buffer_load_dwordx4 v9, s[48:51], s60 offen lds
    s_add_u32 m0, s12, 17408
    s_add_u32 s60, s61, 8192
    buffer_load_dwordx4 v9, s[48:51], s60 offen lds
    s_lshl_b32 s61, s85, 15
    s_add_u32 m0, s12, 20480
    s_add_u32 s60, s61, 0
    buffer_load_dwordx4 v9, s[48:51], s60 offen lds
    s_add_u32 m0, s12, 21504
    s_add_u32 s60, s61, 8192
    buffer_load_dwordx4 v9, s[48:51], s60 offen lds
    s_lshl_b32 s61, s86, 15
    s_add_u32 m0, s12, 24576
    s_add_u32 s60, s61, 0
    buffer_load_dwordx4 v9, s[48:51], s60 offen lds
    s_add_u32 m0, s12, 25600
    s_add_u32 s60, s61, 8192
    buffer_load_dwordx4 v9, s[48:51], s60 offen lds
    s_lshl_b32 s61, s87, 15
    s_add_u32 m0, s12, 28672
    s_add_u32 s60, s61, 0
    buffer_load_dwordx4 v9, s[48:51], s60 offen lds
    s_add_u32 m0, s12, 29696
    s_add_u32 s60, s61, 8192
    buffer_load_dwordx4 v9, s[48:51], s60 offen lds
    s_lshl_b32 s12, s6, 1
    s_add_u32 s12, s12, s8
    s_lshl_b32 s13, s7, 6
    s_lshl_b32 s14, s9, 5
    s_add_u32 s13, s13, s14
    v_and_b32 v8, 31, v0
    s_lshl_b32 s15, s12, 5
    v_add_u32 v8, s15, v8
    v_lshrrev_b32 v9, 5, v0
    v_lshlrev_b32 v11, 2, v8
    v_add_u32 v11, 0x410000, v11
    v_lshlrev_b32 v12, 10, v8
    v_lshl_add_u32 v12, v9, 4, v12
    s_lshl_b32 s13, s13, 1
    v_add_u32 v12, s13, v12
    v_and_b32 v10, 31, v0
    v_min_u32 v3, 16, v10
    v_lshrrev_b32 v4, 4, v3
    v_xor_b32 v4, v4, v9
    v_lshlrev_b32 v3, 5, v3
    v_lshl_add_u32 v3, v4, 4, v3
    s_mul_i32 s11, s9, 9216
    s_add_u32 s11, s11, 131072
    v_add_u32 v3, s11, v3
    v_bfe_u32 v4, v0, 2, 2
    v_lshl_add_u32 v4, v9, 2, v4
    v_lshlrev_b32 v4, 7, v4
    v_bfe_u32 v5, v0, 4, 1
    v_lshl_add_u32 v4, v5, 5, v4
    v_and_b32 v5, 3, v0
    v_lshl_add_u32 v4, v5, 3, v4
    v_bfe_u32 v5, v0, 3, 1
    v_lshl_add_u32 v4, v5, 6, v4
    s_lshl_b32 s11, s8, 6
    v_xor_b32 v10, s11, v4
    s_lshl_b32 s11, s9, 12
    s_add_u32 s11, s11, 149504
    v_add_u32 v10, s11, v10
    s_lshl_b32 s11, s9, 15
    v_add_u32 v4, s11, v4
    s_lshl_b32 s11, s9, 6
    v_xor_b32 v4, s11, v4
    v_xor_b32 v5, 64, v4
    s_lshl_b32 s11, s8, 5
    s_lshl_b32 s14, s9, 4
    s_add_u32 s11, s11, s14
    s_lshl_b32 s11, s11, 10
    s_add_u32 s11, s11, 65536
    v_add_u32 v6, s11, v1
    v_xor_b32 v7, 16384, v6
    v_mov_b32 v184, 0
    v_mov_b32 v185, 0
    v_mov_b32 v186, 0
    v_mov_b32 v187, 0
    v_mov_b32 v188, 0
    v_mov_b32 v189, 0
    v_mov_b32 v190, 0
    v_mov_b32 v191, 0
    v_mov_b32 v192, 0x358637bd
    v_mov_b32 v193, 0x358637bd
    v_mov_b32 v194, 0x358637bd
    v_mov_b32 v195, 0x358637bd
    v_mov_b32 v196, 0x358637bd
    v_mov_b32 v197, 0x358637bd
    v_mov_b32 v198, 0x358637bd
    v_mov_b32 v199, 0x358637bd
    s_mov_b32 s52, s42
    s_mov_b32 s53, s43
    s_mov_b32 s54, 0x200000
    s_mov_b32 s55, 0x20000
    s_barrier
    s_waitcnt vmcnt(0)
    s_barrier
    ds_read_b128 v[16:19], v3 offset:0
    ds_read_b128 v[32:35], v6 offset:0
    ds_read_b128 v[20:23], v3 offset:576
    ds_read_b128 v[36:39], v6 offset:1024
    s_waitcnt lgkmcnt(2)
    v_mfma_f32_32x32x16_bf16 v[64:79], v[16:19], v[32:35], v[184:199]
    ds_read_b64_tr_b16 v[164:165], v5 offset:0
    ds_read_b64_tr_b16 v[166:167], v5 offset:1024
    ds_read_b64_tr_b16 v[160:161], v4 offset:0
    ds_read_b64_tr_b16 v[162:163], v4 offset:1024
    s_waitcnt lgkmcnt(4)
    v_mfma_f32_32x32x16_bf16 v[80:95], v[20:23], v[36:39], v[184:199]
    s_barrier
    ds_read_b128 v[24:27], v3 offset:1152
    ds_read_b128 v[40:43], v6 offset:2048
    s_nop 2
    v_rcp_f32 v72, v72
    ds_read_b128 v[28:31], v3 offset:1728
    ds_read_b128 v[44:47], v6 offset:3072
    ds_read_b64_tr_b16 v[172:173], v5 offset:2048
    ds_read_b64_tr_b16 v[174:175], v5 offset:3072
    v_mul_f32 v64, v64, v72
    v_mul_f32 v65, v65, v72
    v_mul_f32 v66, v66, v72
    v_mul_f32 v67, v67, v72
    v_mul_f32 v68, v68, v72
    ds_read_b64_tr_b16 v[168:169], v4 offset:2048
    ds_read_b64_tr_b16 v[170:171], v4 offset:3072
    v_mul_f32 v69, v69, v72
    v_mul_f32 v70, v70, v72
    v_mul_f32 v71, v71, v72
    v_cvt_pk_bf16_f32 v48, v64, v65
    v_cvt_pk_bf16_f32 v49, v66, v67
    v_cvt_pk_bf16_f32 v50, v68, v69
    v_cvt_pk_bf16_f32 v51, v70, v71
    s_waitcnt lgkmcnt(6)
    v_mfma_f32_32x32x16_bf16 v[64:79], v[24:27], v[40:43], v[184:199]
    ds_read_b64_tr_b16 v[180:181], v5 offset:4096
    ds_read_b64_tr_b16 v[182:183], v5 offset:5120
    v_rcp_f32 v88, v88
    ds_read_b64_tr_b16 v[176:177], v4 offset:4096
    ds_read_b64_tr_b16 v[178:179], v4 offset:5120
    v_mfma_f32_32x32x16_bf16 v[128:143], v[164:167], v[48:51], 0
    v_mul_f32 v80, v80, v88
    v_mul_f32 v81, v81, v88
    v_mul_f32 v82, v82, v88
    v_mul_f32 v83, v83, v88
    v_mul_f32 v84, v84, v88
    v_mfma_f32_32x32x16_bf16 v[112:127], v[160:163], v[48:51], 0
    v_mul_f32 v85, v85, v88
    v_mul_f32 v86, v86, v88
    v_mul_f32 v87, v87, v88
    v_cvt_pk_bf16_f32 v52, v80, v81
    v_cvt_pk_bf16_f32 v53, v82, v83
    v_cvt_pk_bf16_f32 v54, v84, v85
    v_cvt_pk_bf16_f32 v55, v86, v87
    s_waitcnt lgkmcnt(4)
    v_mfma_f32_32x32x16_bf16 v[80:95], v[28:31], v[44:47], v[184:199]
    s_barrier
    ds_read_b128 v[16:19], v3 offset:2304
    ds_read_b128 v[32:35], v6 offset:4096
    v_rcp_f32 v72, v72
    ds_read_b128 v[20:23], v3 offset:2880
    ds_read_b128 v[36:39], v6 offset:5120
    v_mfma_f32_32x32x16_bf16 v[128:143], v[172:175], v[52:55], v[128:143]
    ds_read_b64_tr_b16 v[164:165], v5 offset:6144
    ds_read_b64_tr_b16 v[166:167], v5 offset:7168
    v_mul_f32 v64, v64, v72
    v_mul_f32 v65, v65, v72
    v_mul_f32 v66, v66, v72
    v_mul_f32 v67, v67, v72
    v_mul_f32 v68, v68, v72
    v_mfma_f32_32x32x16_bf16 v[112:127], v[168:171], v[52:55], v[112:127]
    ds_read_b64_tr_b16 v[160:161], v4 offset:6144
    ds_read_b64_tr_b16 v[162:163], v4 offset:7168
    v_mul_f32 v69, v69, v72
    v_mul_f32 v70, v70, v72
    v_mul_f32 v71, v71, v72
    v_cvt_pk_bf16_f32 v48, v64, v65
    v_cvt_pk_bf16_f32 v49, v66, v67
    v_cvt_pk_bf16_f32 v50, v68, v69
    v_cvt_pk_bf16_f32 v51, v70, v71
    s_waitcnt lgkmcnt(6)
    v_mfma_f32_32x32x16_bf16 v[64:79], v[16:19], v[32:35], v[184:199]
    ds_read_b64_tr_b16 v[172:173], v5 offset:8192
    ds_read_b64_tr_b16 v[174:175], v5 offset:9216
    v_rcp_f32 v88, v88
    ds_read_b64_tr_b16 v[168:169], v4 offset:8192
    ds_read_b64_tr_b16 v[170:171], v4 offset:9216
    v_mfma_f32_32x32x16_bf16 v[128:143], v[180:183], v[48:51], v[128:143]
    v_mul_f32 v80, v80, v88
    v_mul_f32 v81, v81, v88
    v_mul_f32 v82, v82, v88
    v_mul_f32 v83, v83, v88
    v_mul_f32 v84, v84, v88
    v_mfma_f32_32x32x16_bf16 v[112:127], v[176:179], v[48:51], v[112:127]
    v_mul_f32 v85, v85, v88
    v_mul_f32 v86, v86, v88
    v_mul_f32 v87, v87, v88
    v_cvt_pk_bf16_f32 v52, v80, v81
    v_cvt_pk_bf16_f32 v53, v82, v83
    v_cvt_pk_bf16_f32 v54, v84, v85
    v_cvt_pk_bf16_f32 v55, v86, v87
    s_waitcnt lgkmcnt(4)
    v_mfma_f32_32x32x16_bf16 v[80:95], v[20:23], v[36:39], v[184:199]
    s_barrier
    ds_read_b128 v[24:27], v3 offset:3456
    ds_read_b128 v[40:43], v6 offset:6144
    v_rcp_f32 v72, v72
    ds_read_b128 v[28:31], v3 offset:4032
    ds_read_b128 v[44:47], v6 offset:7168
    v_mfma_f32_32x32x16_bf16 v[128:143], v[164:167], v[52:55], v[128:143]
    ds_read_b64_tr_b16 v[180:181], v5 offset:10240
    ds_read_b64_tr_b16 v[182:183], v5 offset:11264
    v_mul_f32 v64, v64, v72
    v_mul_f32 v65, v65, v72
    v_mul_f32 v66, v66, v72
    v_mul_f32 v67, v67, v72
    v_mul_f32 v68, v68, v72
    v_mfma_f32_32x32x16_bf16 v[112:127], v[160:163], v[52:55], v[112:127]
    ds_read_b64_tr_b16 v[176:177], v4 offset:10240
    ds_read_b64_tr_b16 v[178:179], v4 offset:11264
    v_mul_f32 v69, v69, v72
    v_mul_f32 v70, v70, v72
    v_mul_f32 v71, v71, v72
    v_cvt_pk_bf16_f32 v48, v64, v65
    v_cvt_pk_bf16_f32 v49, v66, v67
    v_cvt_pk_bf16_f32 v50, v68, v69
    v_cvt_pk_bf16_f32 v51, v70, v71
    s_waitcnt lgkmcnt(6)
    v_mfma_f32_32x32x16_bf16 v[64:79], v[24:27], v[40:43], v[184:199]
    ds_read_b64_tr_b16 v[164:165], v5 offset:12288
    ds_read_b64_tr_b16 v[166:167], v5 offset:13312
    v_rcp_f32 v88, v88
    ds_read_b64_tr_b16 v[160:161], v4 offset:12288
    ds_read_b64_tr_b16 v[162:163], v4 offset:13312
    v_mfma_f32_32x32x16_bf16 v[128:143], v[172:175], v[48:51], v[128:143]
    v_mul_f32 v80, v80, v88
    v_mul_f32 v81, v81, v88
    v_mul_f32 v82, v82, v88
    v_mul_f32 v83, v83, v88
    v_mul_f32 v84, v84, v88
    v_mfma_f32_32x32x16_bf16 v[112:127], v[168:171], v[48:51], v[112:127]
    v_mul_f32 v85, v85, v88
    v_mul_f32 v86, v86, v88
    v_mul_f32 v87, v87, v88
    v_cvt_pk_bf16_f32 v52, v80, v81
    v_cvt_pk_bf16_f32 v53, v82, v83
    v_cvt_pk_bf16_f32 v54, v84, v85
    v_cvt_pk_bf16_f32 v55, v86, v87
    s_waitcnt lgkmcnt(4)
    v_mfma_f32_32x32x16_bf16 v[80:95], v[28:31], v[44:47], v[184:199]
    s_barrier
    ds_read_b128 v[16:19], v3 offset:4608
    ds_read_b128 v[32:35], v6 offset:8192
    v_rcp_f32 v72, v72
    ds_read_b128 v[20:23], v3 offset:5184
    ds_read_b128 v[36:39], v6 offset:9216
    v_mfma_f32_32x32x16_bf16 v[128:143], v[180:183], v[52:55], v[128:143]
    ds_read_b64_tr_b16 v[172:173], v5 offset:14336
    ds_read_b64_tr_b16 v[174:175], v5 offset:15360
    v_mul_f32 v64, v64, v72
    v_mul_f32 v65, v65, v72
    v_mul_f32 v66, v66, v72
    v_mul_f32 v67, v67, v72
    v_mul_f32 v68, v68, v72
    v_mfma_f32_32x32x16_bf16 v[112:127], v[176:179], v[52:55], v[112:127]
    ds_read_b64_tr_b16 v[168:169], v4 offset:14336
    ds_read_b64_tr_b16 v[170:171], v4 offset:15360
    v_mul_f32 v69, v69, v72
    v_mul_f32 v70, v70, v72
    v_mul_f32 v71, v71, v72
    v_cvt_pk_bf16_f32 v48, v64, v65
    v_cvt_pk_bf16_f32 v49, v66, v67
    v_cvt_pk_bf16_f32 v50, v68, v69
    v_cvt_pk_bf16_f32 v51, v70, v71
    s_waitcnt lgkmcnt(6)
    v_mfma_f32_32x32x16_bf16 v[64:79], v[16:19], v[32:35], v[184:199]
    ds_read_b64_tr_b16 v[180:181], v5 offset:16384
    ds_read_b64_tr_b16 v[182:183], v5 offset:17408
    v_rcp_f32 v88, v88
    ds_read_b64_tr_b16 v[176:177], v4 offset:16384
    ds_read_b64_tr_b16 v[178:179], v4 offset:17408
    v_mfma_f32_32x32x16_bf16 v[128:143], v[164:167], v[48:51], v[128:143]
    v_mul_f32 v80, v80, v88
    v_mul_f32 v81, v81, v88
    v_mul_f32 v82, v82, v88
    v_mul_f32 v83, v83, v88
    v_mul_f32 v84, v84, v88
    v_mfma_f32_32x32x16_bf16 v[112:127], v[160:163], v[48:51], v[112:127]
    v_mul_f32 v85, v85, v88
    v_mul_f32 v86, v86, v88
    v_mul_f32 v87, v87, v88
    v_cvt_pk_bf16_f32 v52, v80, v81
    v_cvt_pk_bf16_f32 v53, v82, v83
    v_cvt_pk_bf16_f32 v54, v84, v85
    v_cvt_pk_bf16_f32 v55, v86, v87
    s_waitcnt lgkmcnt(4)
    v_mfma_f32_32x32x16_bf16 v[80:95], v[20:23], v[36:39], v[184:199]
    s_barrier
    ds_read_b128 v[24:27], v3 offset:5760
    ds_read_b128 v[40:43], v6 offset:10240
    v_rcp_f32 v72, v72
    ds_read_b128 v[28:31], v3 offset:6336
    ds_read_b128 v[44:47], v6 offset:11264
    v_mfma_f32_32x32x16_bf16 v[128:143], v[172:175], v[52:55], v[128:143]
    ds_read_b64_tr_b16 v[164:165], v5 offset:18432
    ds_read_b64_tr_b16 v[166:167], v5 offset:19456
    v_mul_f32 v64, v64, v72
    v_mul_f32 v65, v65, v72
    v_mul_f32 v66, v66, v72
    v_mul_f32 v67, v67, v72
    v_mul_f32 v68, v68, v72
    v_mfma_f32_32x32x16_bf16 v[112:127], v[168:171], v[52:55], v[112:127]
    ds_read_b64_tr_b16 v[160:161], v4 offset:18432
    ds_read_b64_tr_b16 v[162:163], v4 offset:19456
    v_mul_f32 v69, v69, v72
    v_mul_f32 v70, v70, v72
    v_mul_f32 v71, v71, v72
    v_cvt_pk_bf16_f32 v48, v64, v65
    v_cvt_pk_bf16_f32 v49, v66, v67
    v_cvt_pk_bf16_f32 v50, v68, v69
    v_cvt_pk_bf16_f32 v51, v70, v71
    s_waitcnt lgkmcnt(6)
    v_mfma_f32_32x32x16_bf16 v[64:79], v[24:27], v[40:43], v[184:199]
    ds_read_b64_tr_b16 v[172:173], v5 offset:20480
    ds_read_b64_tr_b16 v[174:175], v5 offset:21504
    v_rcp_f32 v88, v88
    ds_read_b64_tr_b16 v[168:169], v4 offset:20480
    ds_read_b64_tr_b16 v[170:171], v4 offset:21504
    v_mfma_f32_32x32x16_bf16 v[128:143], v[180:183], v[48:51], v[128:143]
    v_mul_f32 v80, v80, v88
    v_mul_f32 v81, v81, v88
    v_mul_f32 v82, v82, v88
    v_mul_f32 v83, v83, v88
    v_mul_f32 v84, v84, v88
    v_mfma_f32_32x32x16_bf16 v[112:127], v[176:179], v[48:51], v[112:127]
    v_mul_f32 v85, v85, v88
    v_mul_f32 v86, v86, v88
    v_mul_f32 v87, v87, v88
    v_cvt_pk_bf16_f32 v52, v80, v81
    v_cvt_pk_bf16_f32 v53, v82, v83
    v_cvt_pk_bf16_f32 v54, v84, v85
    v_cvt_pk_bf16_f32 v55, v86, v87
    s_waitcnt lgkmcnt(4)
    v_mfma_f32_32x32x16_bf16 v[80:95], v[28:31], v[44:47], v[184:199]
    s_barrier
    ds_read_b128 v[16:19], v3 offset:6912
    ds_read_b128 v[32:35], v6 offset:12288
    v_rcp_f32 v72, v72
    ds_read_b128 v[20:23], v3 offset:7488
    ds_read_b128 v[36:39], v6 offset:13312
    v_mfma_f32_32x32x16_bf16 v[128:143], v[164:167], v[52:55], v[128:143]
    ds_read_b64_tr_b16 v[180:181], v5 offset:22528
    ds_read_b64_tr_b16 v[182:183], v5 offset:23552
    v_mul_f32 v64, v64, v72
    v_mul_f32 v65, v65, v72
    v_mul_f32 v66, v66, v72
    v_mul_f32 v67, v67, v72
    v_mul_f32 v68, v68, v72
    v_mfma_f32_32x32x16_bf16 v[112:127], v[160:163], v[52:55], v[112:127]
    ds_read_b64_tr_b16 v[176:177], v4 offset:22528
    ds_read_b64_tr_b16 v[178:179], v4 offset:23552
    v_mul_f32 v69, v69, v72
    v_mul_f32 v70, v70, v72
    v_mul_f32 v71, v71, v72
    v_cvt_pk_bf16_f32 v48, v64, v65
    v_cvt_pk_bf16_f32 v49, v66, v67
    v_cvt_pk_bf16_f32 v50, v68, v69
    v_cvt_pk_bf16_f32 v51, v70, v71
    s_waitcnt lgkmcnt(6)
    v_mfma_f32_32x32x16_bf16 v[64:79], v[16:19], v[32:35], v[184:199]
    buffer_load_dword v13, v11, s[56:59], 0 offen sc1
    ds_read_b64_tr_b16 v[164:165], v5 offset:24576
    ds_read_b64_tr_b16 v[166:167], v5 offset:25600
    v_rcp_f32 v88, v88
    ds_read_b64_tr_b16 v[160:161], v4 offset:24576
    ds_read_b64_tr_b16 v[162:163], v4 offset:25600
    v_mfma_f32_32x32x16_bf16 v[128:143], v[172:175], v[48:51], v[128:143]
    v_mul_f32 v80, v80, v88
    v_mul_f32 v81, v81, v88
    v_mul_f32 v82, v82, v88
    v_mul_f32 v83, v83, v88
    v_mul_f32 v84, v84, v88
    v_mfma_f32_32x32x16_bf16 v[112:127], v[168:171], v[48:51], v[112:127]
    v_mul_f32 v85, v85, v88
    v_mul_f32 v86, v86, v88
    v_mul_f32 v87, v87, v88
    v_cvt_pk_bf16_f32 v52, v80, v81
    v_cvt_pk_bf16_f32 v53, v82, v83
    v_cvt_pk_bf16_f32 v54, v84, v85
    v_cvt_pk_bf16_f32 v55, v86, v87
    s_waitcnt lgkmcnt(4)
    v_mfma_f32_32x32x16_bf16 v[80:95], v[20:23], v[36:39], v[184:199]
    s_barrier
    ds_read_b128 v[24:27], v3 offset:8064
    ds_read_b128 v[40:43], v6 offset:14336
    v_rcp_f32 v72, v72
    ds_read_b128 v[28:31], v3 offset:8640
    ds_read_b128 v[44:47], v6 offset:15360
    v_mfma_f32_32x32x16_bf16 v[128:143], v[180:183], v[52:55], v[128:143]
    ds_read_b64_tr_b16 v[172:173], v5 offset:26624
    ds_read_b64_tr_b16 v[174:175], v5 offset:27648
    v_mul_f32 v64, v64, v72
    v_mul_f32 v65, v65, v72
    v_mul_f32 v66, v66, v72
    v_mul_f32 v67, v67, v72
    v_mul_f32 v68, v68, v72
    v_mfma_f32_32x32x16_bf16 v[112:127], v[176:179], v[52:55], v[112:127]
    ds_read_b64_tr_b16 v[168:169], v4 offset:26624
    ds_read_b64_tr_b16 v[170:171], v4 offset:27648
    v_mul_f32 v69, v69, v72
    v_mul_f32 v70, v70, v72
    v_mul_f32 v71, v71, v72
    v_cvt_pk_bf16_f32 v48, v64, v65
    v_cvt_pk_bf16_f32 v49, v66, v67
    v_cvt_pk_bf16_f32 v50, v68, v69
    v_cvt_pk_bf16_f32 v51, v70, v71
    s_waitcnt lgkmcnt(6)
    v_mfma_f32_32x32x16_bf16 v[64:79], v[24:27], v[40:43], v[184:199]
    ds_read_b64_tr_b16 v[180:181], v5 offset:28672
    ds_read_b64_tr_b16 v[182:183], v5 offset:29696
    v_rcp_f32 v88, v88
    ds_read_b64_tr_b16 v[176:177], v4 offset:28672
    ds_read_b64_tr_b16 v[178:179], v4 offset:29696
    v_mfma_f32_32x32x16_bf16 v[128:143], v[164:167], v[48:51], v[128:143]
    v_mul_f32 v80, v80, v88
    v_mul_f32 v81, v81, v88
    v_mul_f32 v82, v82, v88
    v_mul_f32 v83, v83, v88
    v_mul_f32 v84, v84, v88
    v_mfma_f32_32x32x16_bf16 v[112:127], v[160:163], v[48:51], v[112:127]
    v_mul_f32 v85, v85, v88
    v_mul_f32 v86, v86, v88
    v_mul_f32 v87, v87, v88
    v_cvt_pk_bf16_f32 v52, v80, v81
    v_cvt_pk_bf16_f32 v53, v82, v83
    v_cvt_pk_bf16_f32 v54, v84, v85
    v_cvt_pk_bf16_f32 v55, v86, v87
    s_waitcnt lgkmcnt(4)
    v_mfma_f32_32x32x16_bf16 v[80:95], v[28:31], v[44:47], v[184:199]
    ds_read_b64_tr_b16 v[164:165], v5 offset:30720
    ds_read_b64_tr_b16 v[166:167], v5 offset:31744
    v_rcp_f32 v72, v72
    ds_read_b64_tr_b16 v[160:161], v4 offset:30720
    ds_read_b64_tr_b16 v[162:163], v4 offset:31744
    v_mfma_f32_32x32x16_bf16 v[128:143], v[172:175], v[52:55], v[128:143]
    v_mul_f32 v64, v64, v72
    v_mul_f32 v65, v65, v72
    v_mul_f32 v66, v66, v72
    v_mul_f32 v67, v67, v72
    v_mul_f32 v68, v68, v72
    v_mfma_f32_32x32x16_bf16 v[112:127], v[168:171], v[52:55], v[112:127]
    v_mul_f32 v69, v69, v72
    v_mul_f32 v70, v70, v72
    v_mul_f32 v71, v71, v72
    v_cvt_pk_bf16_f32 v48, v64, v65
    v_cvt_pk_bf16_f32 v49, v66, v67
    v_cvt_pk_bf16_f32 v50, v68, v69
    v_cvt_pk_bf16_f32 v51, v70, v71
    s_waitcnt lgkmcnt(4)
    s_barrier
    ds_read_b64_tr_b16 v[96:97], v10 offset:0
    ds_read_b64_tr_b16 v[98:99], v10 offset:1024
    v_rcp_f32 v88, v88
    ds_read_b64_tr_b16 v[100:101], v10 offset:2048
    ds_read_b64_tr_b16 v[102:103], v10 offset:3072
    v_mfma_f32_32x32x16_bf16 v[128:143], v[180:183], v[48:51], v[128:143]
    v_mul_f32 v80, v80, v88
    v_mul_f32 v81, v81, v88
    v_mul_f32 v82, v82, v88
    v_mul_f32 v83, v83, v88
    v_mul_f32 v84, v84, v88
    v_mfma_f32_32x32x16_bf16 v[112:127], v[176:179], v[48:51], v[112:127]
    v_mul_f32 v85, v85, v88
    v_mul_f32 v86, v86, v88
    v_mul_f32 v87, v87, v88
    v_cvt_pk_bf16_f32 v52, v80, v81
    v_cvt_pk_bf16_f32 v53, v82, v83
    v_cvt_pk_bf16_f32 v54, v84, v85
    v_cvt_pk_bf16_f32 v55, v86, v87
    s_waitcnt lgkmcnt(4)
    s_nop 0
    v_mfma_f32_32x32x16_bf16 v[128:143], v[164:167], v[52:55], v[128:143]
    v_mfma_f32_32x32x16_bf16 v[112:127], v[160:163], v[52:55], v[112:127]
    s_waitcnt vmcnt(0) lgkmcnt(0)
    v_sub_f32 v14, 1.0, v13
    v_lshlrev_b32 v144, 16, v96
    v_and_b32 v145, 0xffff0000, v96
    v_lshlrev_b32 v146, 16, v97
    v_and_b32 v147, 0xffff0000, v97
    v_lshlrev_b32 v148, 16, v98
    v_and_b32 v149, 0xffff0000, v98
    v_lshlrev_b32 v150, 16, v99
    v_and_b32 v151, 0xffff0000, v99
    s_nop 0
    ds_write_b128 v6, v[128:131] offset:0
    ds_write_b128 v6, v[132:135] offset:1024
    ds_write_b128 v6, v[136:139] offset:2048
    ds_write_b128 v6, v[140:143] offset:3072
    v_lshlrev_b32 v152, 16, v100
    v_and_b32 v153, 0xffff0000, v100
    v_lshlrev_b32 v154, 16, v101
    v_and_b32 v155, 0xffff0000, v101
    v_lshlrev_b32 v156, 16, v102
    v_and_b32 v157, 0xffff0000, v102
    v_lshlrev_b32 v158, 16, v103
    v_and_b32 v159, 0xffff0000, v103
    s_waitcnt lgkmcnt(0)
    s_barrier
    ds_read_b128 v[16:19], v7 offset:0
    ds_read_b128 v[20:23], v7 offset:1024
    ds_read_b128 v[24:27], v7 offset:2048
    ds_read_b128 v[28:31], v7 offset:3072
    v_mov_b32 v15, v14
    v_mov_b32 v56, v13
    v_mov_b32 v57, v13
    v_pk_mul_f32 v[144:145], v[14:15], v[144:145]
    v_pk_mul_f32 v[146:147], v[14:15], v[146:147]
    v_pk_mul_f32 v[148:149], v[14:15], v[148:149]
    v_pk_mul_f32 v[150:151], v[14:15], v[150:151]
    v_pk_mul_f32 v[152:153], v[14:15], v[152:153]
    v_pk_mul_f32 v[154:155], v[14:15], v[154:155]
    v_pk_mul_f32 v[156:157], v[14:15], v[156:157]
    v_pk_mul_f32 v[158:159], v[14:15], v[158:159]
    v_pk_fma_f32 v[144:145], v[56:57], v[112:113], v[144:145]
    v_pk_fma_f32 v[146:147], v[56:57], v[114:115], v[146:147]
    v_pk_fma_f32 v[148:149], v[56:57], v[116:117], v[148:149]
    v_pk_fma_f32 v[150:151], v[56:57], v[118:119], v[150:151]
    v_pk_fma_f32 v[152:153], v[56:57], v[120:121], v[152:153]
    v_pk_fma_f32 v[154:155], v[56:57], v[122:123], v[154:155]
    v_pk_fma_f32 v[156:157], v[56:57], v[124:125], v[156:157]
    v_pk_fma_f32 v[158:159], v[56:57], v[126:127], v[158:159]
    s_waitcnt lgkmcnt(2)
    v_pk_fma_f32 v[144:145], v[56:57], v[16:17], v[144:145]
    v_pk_fma_f32 v[146:147], v[56:57], v[18:19], v[146:147]
    v_pk_fma_f32 v[148:149], v[56:57], v[20:21], v[148:149]
    v_pk_fma_f32 v[150:151], v[56:57], v[22:23], v[150:151]
    v_cvt_pk_bf16_f32 v32, v144, v145
    v_cvt_pk_bf16_f32 v33, v146, v147
    v_cvt_pk_bf16_f32 v34, v148, v149
    v_cvt_pk_bf16_f32 v35, v150, v151
    s_nop 0
    v_permlane32_swap_b32 v32, v34
    v_permlane32_swap_b32 v33, v35
    buffer_store_dwordx4 v[32:35], v12, s[52:55], 0 offen offset:0
    s_waitcnt lgkmcnt(0)
    v_pk_fma_f32 v[152:153], v[56:57], v[24:25], v[152:153]
    v_pk_fma_f32 v[154:155], v[56:57], v[26:27], v[154:155]
    v_pk_fma_f32 v[156:157], v[56:57], v[28:29], v[156:157]
    v_pk_fma_f32 v[158:159], v[56:57], v[30:31], v[158:159]
    v_cvt_pk_bf16_f32 v36, v152, v153
    v_cvt_pk_bf16_f32 v37, v154, v155
    v_cvt_pk_bf16_f32 v38, v156, v157
    v_cvt_pk_bf16_f32 v39, v158, v159
    s_nop 0
    v_permlane32_swap_b32 v36, v38
    v_permlane32_swap_b32 v37, v39
    buffer_store_dwordx4 v[36:39], v12, s[52:55], 0 offen offset:32
K2_END:
    s_endpgm
.p2align 8
.type K1_TABLE,@object
K1_TABLE:
.long 0x0, 0x8650, 0x8fc0, 0x6f80, 0x210, 0x818c, 0x8afc, 0x6fa0
.long 0x420, 0x864c, 0x8fbc, 0x6fc0, 0x630, 0x8188, 0x8af8, 0x6fe0
.long 0x1290, 0x8648, 0x8fb8, 0x7000, 0x1290, 0x8184, 0x8af4, 0x7020
.long 0x14a0, 0x8644, 0x8fb4, 0x7040, 0x16b0, 0x8180, 0x8af0, 0x7060
.long 0x840, 0x8640, 0x8fb0, 0x7080, 0xa50, 0x817c, 0x8aec, 0x70a0
.long 0xc60, 0x863c, 0x8fac, 0x70c0, 0xe70, 0x8178, 0x8ae8, 0x70e0
.long 0x16b0, 0x8638, 0x8fa8, 0x7100, 0x16b0, 0x8174, 0x8ae4, 0x7120
.long 0x18c0, 0x8634, 0x8fa4, 0x7140, 0x1ad0, 0x8170, 0x8ae0, 0x7160
.long 0x1080, 0x8660, 0x8fc8, 0x6f90, 0x1ce0, 0x819c, 0x8b04, 0x6fb0
.long 0x1ef0, 0x865c, 0x8fc4, 0x6fd0, 0x2100, 0x8198, 0x8b00, 0x6ff0
.long 0x1ad0, 0x8658, 0x8fc0, 0x7010, 0x2520, 0x8194, 0x8afc, 0x7030
.long 0x2730, 0x8654, 0x8fbc, 0x7050, 0x2940, 0x8190, 0x8af8, 0x7070
.long 0x2310, 0x8650, 0x8fb8, 0x7090, 0x0, 0x818c, 0x8af4, 0x70b0
.long 0x0, 0x864c, 0x8fb4, 0x70d0, 0x0, 0x8188, 0x8af0, 0x70f0
.long 0x2b50, 0x8648, 0x8fb0, 0x7110, 0x0, 0x8184, 0x8aec, 0x7130
.long 0x0, 0x8644, 0x8fac, 0x7150, 0x0, 0x8180, 0x8ae8, 0x7170
.long 0x10, 0x8670, 0x8fd0, 0x6fa0, 0x220, 0x81ac, 0x8b0c, 0x6fc0
.long 0x430, 0x866c, 0x8fcc, 0x6fe0, 0x640, 0x81a8, 0x8b08, 0x7000
.long 0x12a0, 0x8668, 0x8fc8, 0x7020, 0x12a0, 0x81a4, 0x8b04, 0x7040
.long 0x14b0, 0x8664, 0x8fc4, 0x7060, 0x16c0, 0x81a0, 0x8b00, 0x7080
.long 0x850, 0x8660, 0x8fc0, 0x70a0, 0xa60, 0x819c, 0x8afc, 0x70c0
.long 0xc70, 0x865c, 0x8fbc, 0x70e0, 0xe80, 0x8198, 0x8af8, 0x7100
.long 0x16c0, 0x8658, 0x8fb8, 0x7120, 0x16c0, 0x8194, 0x8af4, 0x7140
.long 0x18d0, 0x8654, 0x8fb4, 0x7160, 0x1ae0, 0x8190, 0x8af0, 0x7180
.long 0x1090, 0x8680, 0x8fd8, 0x6fb0, 0x1cf0, 0x81bc, 0x8b14, 0x6fd0
.long 0x1f00, 0x867c, 0x8fd4, 0x6ff0, 0x2110, 0x81b8, 0x8b10, 0x7010
.long 0x1ae0, 0x8678, 0x8fd0, 0x7030, 0x2530, 0x81b4, 0x8b0c, 0x7050
.long 0x2740, 0x8674, 0x8fcc, 0x7070, 0x2950, 0x81b0, 0x8b08, 0x7090
.long 0x2320, 0x8670, 0x8fc8, 0x70b0, 0x10, 0x81ac, 0x8b04, 0x70d0
.long 0x10, 0x866c, 0x8fc4, 0x70f0, 0x10, 0x81a8, 0x8b00, 0x7110
.long 0x2b60, 0x8668, 0x8fc0, 0x7130, 0x10, 0x81a4, 0x8afc, 0x7150
.long 0x10, 0x8664, 0x8fbc, 0x7170, 0x10, 0x81a0, 0x8af8, 0x7190
.long 0x8b3e, 0x8bfe, 0x8b1e, 0x8bde, 0x8cbe, 0x8d7e, 0x8c9e, 0x8d5e
.long 0x8b3c, 0x8bfc, 0x8b1c, 0x8bdc, 0x8cbc, 0x8d7c, 0x8c9c, 0x8d5c
.long 0x8b3a, 0x8bfa, 0x8b1a, 0x8bda, 0x8cba, 0x8d7a, 0x8c9a, 0x8d5a
.long 0x8b38, 0x8bf8, 0x8b18, 0x8bd8, 0x8cb8, 0x8d78, 0x8c98, 0x8d58
.long 0x8b36, 0x8bf6, 0x8b16, 0x8bd6, 0x8cb6, 0x8d76, 0x8c96, 0x8d56
.long 0x8b34, 0x8bf4, 0x8b14, 0x8bd4, 0x8cb4, 0x8d74, 0x8c94, 0x8d54
.long 0x8b32, 0x8bf2, 0x8b12, 0x8bd2, 0x8cb2, 0x8d72, 0x8c92, 0x8d52
.long 0x8b30, 0x8bf0, 0x8b10, 0x8bd0, 0x8cb0, 0x8d70, 0x8c90, 0x8d50
.long 0x8b2e, 0x8bee, 0x8b0e, 0x8bce, 0x8cae, 0x8d6e, 0x8c8e, 0x8d4e
.long 0x8b2c, 0x8bec, 0x8b0c, 0x8bcc, 0x8cac, 0x8d6c, 0x8c8c, 0x8d4c
.long 0x8b2a, 0x8bea, 0x8b0a, 0x8bca, 0x8caa, 0x8d6a, 0x8c8a, 0x8d4a
.long 0x8b28, 0x8be8, 0x8b08, 0x8bc8, 0x8ca8, 0x8d68, 0x8c88, 0x8d48
.long 0x8b26, 0x8be6, 0x8b06, 0x8bc6, 0x8ca6, 0x8d66, 0x8c86, 0x8d46
.long 0x8b24, 0x8be4, 0x8b04, 0x8bc4, 0x8ca4, 0x8d64, 0x8c84, 0x8d44
.long 0x8b22, 0x8be2, 0x8b02, 0x8bc2, 0x8ca2, 0x8d62, 0x8c82, 0x8d42
.long 0x8b20, 0x8be0, 0x8b00, 0x8bc0, 0x8ca0, 0x8d60, 0x8c80, 0x8d40
.long 0x8e5e, 0x8e3e, 0x8e1e, 0x8dfe, 0x8f1e, 0x8efe, 0x8ede, 0x8ebe
.long 0x8e5c, 0x8e3c, 0x8e1c, 0x8dfc, 0x8f1c, 0x8efc, 0x8edc, 0x8ebc
.long 0x8e5a, 0x8e3a, 0x8e1a, 0x8dfa, 0x8f1a, 0x8efa, 0x8eda, 0x8eba
.long 0x8e58, 0x8e38, 0x8e18, 0x8df8, 0x8f18, 0x8ef8, 0x8ed8, 0x8eb8
.long 0x8e56, 0x8e36, 0x8e16, 0x8df6, 0x8f16, 0x8ef6, 0x8ed6, 0x8eb6
.long 0x8e54, 0x8e34, 0x8e14, 0x8df4, 0x8f14, 0x8ef4, 0x8ed4, 0x8eb4
.long 0x8e52, 0x8e32, 0x8e12, 0x8df2, 0x8f12, 0x8ef2, 0x8ed2, 0x8eb2
.long 0x8e50, 0x8e30, 0x8e10, 0x8df0, 0x8f10, 0x8ef0, 0x8ed0, 0x8eb0
.long 0x8e4e, 0x8e2e, 0x8e0e, 0x8dee, 0x8f0e, 0x8eee, 0x8ece, 0x8eae
.long 0x8e4c, 0x8e2c, 0x8e0c, 0x8dec, 0x8f0c, 0x8eec, 0x8ecc, 0x8eac
.long 0x8e4a, 0x8e2a, 0x8e0a, 0x8dea, 0x8f0a, 0x8eea, 0x8eca, 0x8eaa
.long 0x8e48, 0x8e28, 0x8e08, 0x8de8, 0x8f08, 0x8ee8, 0x8ec8, 0x8ea8
.long 0x8e46, 0x8e26, 0x8e06, 0x8de6, 0x8f06, 0x8ee6, 0x8ec6, 0x8ea6
.long 0x8e44, 0x8e24, 0x8e04, 0x8de4, 0x8f04, 0x8ee4, 0x8ec4, 0x8ea4
.long 0x8e42, 0x8e22, 0x8e02, 0x8de2, 0x8f02, 0x8ee2, 0x8ec2, 0x8ea2
.long 0x8e40, 0x8e20, 0x8e00, 0x8de0, 0x8f00, 0x8ee0, 0x8ec0, 0x8ea0
.long 0x0, 0x0, 0x0, 0x0, 0x0, 0x0, 0x0, 0x0
.long 0x0, 0x0, 0x0, 0x0, 0x0, 0x0, 0x0, 0x0
.long 0x0, 0x0, 0x0, 0x0, 0x0, 0x0, 0x0, 0x0
.long 0x0, 0x0, 0x0, 0x0, 0x0, 0x0, 0x0, 0x0
.long 0x0, 0x0, 0x0, 0x0, 0x0, 0x0, 0x0, 0x0
.long 0x0, 0x0, 0x0, 0x0, 0x0, 0x0, 0x0, 0x0
.long 0x0, 0x0, 0x0, 0x0, 0x0, 0x0, 0x0, 0x0
.long 0x0, 0x0, 0x0, 0x0, 0x0, 0x0, 0x0, 0x0
.long 0x0, 0x0, 0xffffffff, 0x0, 0x0, 0x0, 0xffff0000, 0xffff
.long 0x0, 0x0, 0x0, 0xffffffff, 0x0, 0x0, 0x0, 0xffff0000
.long 0x0, 0x0, 0x0, 0x0, 0x0, 0x0, 0x0, 0x0
.long 0x0, 0x0, 0x0, 0x0, 0x0, 0x0, 0x0, 0x0
.long 0x0, 0x0, 0x0, 0x0, 0x0, 0x0, 0x0, 0x0
.long 0x0, 0x0, 0x0, 0x0, 0x0, 0x0, 0x0, 0x0
.long 0x0, 0x0, 0x0, 0x0, 0x0, 0x0, 0x0, 0x0
.long 0x0, 0x0, 0x0, 0x0, 0x0, 0x0, 0x0, 0x0
.long 0x0, 0x0, 0x0, 0x0, 0x0, 0x0, 0x0, 0x0
.long 0x0, 0x0, 0x0, 0x0, 0xffff, 0x0, 0x0, 0x0
.long 0xffffffff, 0x0, 0x0, 0x0, 0xffff0000, 0xffff, 0x0, 0x0
.long 0x0, 0xffffffff, 0x0, 0x0, 0x0, 0xffff0000, 0xffff, 0x0
.long 0x0, 0x0, 0xffffffff, 0x0, 0x0, 0x0, 0xffff0000, 0xffff
.long 0x0, 0x0, 0x0, 0xffffffff, 0x0, 0x0, 0x0, 0xffff0000
.long 0x0, 0x0, 0x0, 0x0, 0x0, 0x0, 0x0, 0x0
.long 0x0, 0x0, 0x0, 0x0, 0x0, 0x0, 0x0, 0x0
.long 0x0, 0x0, 0x0, 0x0, 0x0, 0x0, 0x0, 0x0
.long 0x0, 0x0, 0x0, 0x0, 0x0, 0x0, 0x0, 0x0
.long 0x0, 0x0, 0x0, 0x0, 0x0, 0x0, 0x0, 0x0
.long 0x0, 0x0, 0x0, 0x0, 0x0, 0x0, 0x0, 0x0
.long 0x0, 0x0, 0x0, 0x0, 0x0, 0x0, 0x0, 0x0
.long 0x0, 0x0, 0x0, 0x0, 0xffff, 0x0, 0x0, 0x0
.long 0xffffffff, 0x0, 0x0, 0x0, 0xffff0000, 0xffff, 0x0, 0x0
.long 0x0, 0xffffffff, 0x0, 0x0, 0x0, 0xffff0000, 0xffff, 0x0
.long 0x0, 0x0, 0x0, 0x0, 0x0, 0x0, 0x0, 0x0
.long 0x0, 0x0, 0x0, 0x0, 0x0, 0x0, 0x0, 0x0
.long 0x0, 0x0, 0x0, 0x0, 0x0, 0x0, 0x0, 0x0
.long 0x0, 0x0, 0x0, 0x0, 0x0, 0x0, 0x0, 0x0
.long 0x0, 0x0, 0x0, 0x0, 0x0, 0x0, 0x0, 0x0
.long 0x0, 0x0, 0x0, 0x0, 0x0, 0x0, 0x0, 0x0
.long 0x0, 0x0, 0x0, 0x0, 0x0, 0x0, 0x0, 0x0
.long 0x0, 0x0, 0x0, 0x0, 0x0, 0x0, 0x0, 0x0
.long 0x0, 0x3f800000, 0x3f803f80, 0x0, 0x0, 0x0, 0x3f803f80, 0x3f80
.long 0x0, 0x0, 0x3f800000, 0x3f803f80, 0x0, 0x0, 0x0, 0x3f803f80
.long 0x0, 0x0, 0x0, 0x3f800000, 0x0, 0x0, 0x0, 0x0
.long 0x0, 0x0, 0x0, 0x0, 0x0, 0x0, 0x0, 0x0
.long 0x0, 0x0, 0x0, 0x0, 0x0, 0x0, 0x0, 0x0
.long 0x0, 0x0, 0x0, 0x0, 0x0, 0x0, 0x0, 0x0
.long 0x0, 0x0, 0x0, 0x0, 0x0, 0x0, 0x0, 0x0
.long 0x0, 0x0, 0x0, 0x0, 0x0, 0x0, 0x0, 0x0
.long 0x0, 0x0, 0x0, 0x0, 0x0, 0x0, 0x0, 0x0
.long 0x0, 0x0, 0x0, 0x0, 0x3f80, 0x0, 0x0, 0x0
.long 0x3f803f80, 0x0, 0x0, 0x0, 0x3f803f80, 0x3f80, 0x0, 0x0
.long 0x3f800000, 0x3f803f80, 0x0, 0x0, 0x0, 0x3f803f80, 0x3f80, 0x0
.long 0x0, 0x3f800000, 0x3f803f80, 0x0, 0x0, 0x0, 0x3f803f80, 0x3f80
.long 0x0, 0x0, 0x3f800000, 0x3f803f80, 0x0, 0x0, 0x0, 0x3f803f80
.long 0x0, 0x0, 0x0, 0x3f800000, 0x0, 0x0, 0x0, 0x0
.long 0x0, 0x0, 0x0, 0x0, 0x0, 0x0, 0x0, 0x0
.long 0x0, 0x0, 0x0, 0x0, 0x0, 0x0, 0x0, 0x0
.long 0x0, 0x0, 0x0, 0x0, 0x0, 0x0, 0x0, 0x0
.long 0x0, 0x0, 0x0, 0x0, 0x0, 0x0, 0x0, 0x0
.long 0x0, 0x0, 0x0, 0x0, 0x0, 0x0, 0x0, 0x0
.long 0x0, 0x0, 0x0, 0x0, 0x0, 0x0, 0x0, 0x0
.long 0x0, 0x0, 0x0, 0x0, 0x3f80, 0x0, 0x0, 0x0
.long 0x3f803f80, 0x0, 0x0, 0x0, 0x3f803f80, 0x3f80, 0x0, 0x0
.long 0x3f800000, 0x3f803f80, 0x0, 0x0, 0x0, 0x3f803f80, 0x3f80, 0x0
.long 0x0, 0x0, 0x0, 0x3f803f80, 0x0, 0x0, 0x0, 0x3f800000
.long 0x0, 0x0, 0x0, 0x0, 0x0, 0x0, 0x0, 0x0
.long 0x0, 0x0, 0x0, 0x0, 0x0, 0x0, 0x0, 0x0
.long 0x0, 0x0, 0x0, 0x0, 0x0, 0x0, 0x0, 0x0
.long 0x0, 0x0, 0x0, 0x0, 0x0, 0x0, 0x0, 0x0
.long 0x0, 0x0, 0x0, 0x0, 0x0, 0x0, 0x0, 0x0
.long 0x0, 0x0, 0x0, 0x0, 0x0, 0x0, 0x0, 0x0
.long 0x0, 0x0, 0x0, 0x0, 0x0, 0x0, 0x0, 0x0
.long 0x3f803f80, 0x3f80, 0x0, 0x0, 0x3f803f80, 0x3f803f80, 0x0, 0x0
.long 0x3f803f80, 0x3f803f80, 0x3f80, 0x0, 0x3f800000, 0x3f803f80, 0x3f803f80, 0x0
.long 0x0, 0x3f803f80, 0x3f803f80, 0x3f80, 0x0, 0x3f800000, 0x3f803f80, 0x3f803f80
.long 0x0, 0x0, 0x3f803f80, 0x3f803f80, 0x0, 0x0, 0x3f800000, 0x3f803f80
.long 0x0, 0x0, 0x0, 0x3f803f80, 0x0, 0x0, 0x0, 0x3f800000
.long 0x0, 0x0, 0x0, 0x0, 0x0, 0x0, 0x0, 0x0
.long 0x0, 0x0, 0x0, 0x0, 0x0, 0x0, 0x0, 0x0
.long 0x0, 0x0, 0x0, 0x0, 0x0, 0x0, 0x0, 0x0
.long 0x0, 0x0, 0x0, 0x0, 0x0, 0x0, 0x0, 0x0
.long 0x0, 0x0, 0x0, 0x0, 0x0, 0x0, 0x0, 0x0
.long 0x0, 0x0, 0x0, 0x0, 0x0, 0x0, 0x0, 0x0
.long 0x3f80, 0x0, 0x0, 0x0, 0x3f803f80, 0x0, 0x0, 0x0
.long 0x3f803f80, 0x3f80, 0x0, 0x0, 0x3f803f80, 0x3f803f80, 0x0, 0x0
.long 0x3f803f80, 0x3f803f80, 0x3f80, 0x0, 0x3f800000, 0x3f803f80, 0x3f803f80, 0x0
.long 0x0, 0x3f803f80, 0x3f803f80, 0x3f80, 0x0, 0x3f800000, 0x3f803f80, 0x3f803f80
.long 0x0, 0x0, 0x3f803f80, 0x3f803f80, 0x0, 0x0, 0x3f800000, 0x3f803f80
.long 0x0, 0x0, 0x0, 0x0, 0x0, 0x0, 0x0, 0x0
.long 0x0, 0x0, 0x0, 0x0, 0x0, 0x0, 0x0, 0x0
.long 0x0, 0x0, 0x0, 0x0, 0x0, 0x0, 0x0, 0x0
.long 0x0, 0x0, 0x0, 0x0, 0x0, 0x0, 0x0, 0x0
.long 0x0, 0x0, 0x0, 0x0, 0x0, 0x0, 0x0, 0x0
.long 0x0, 0x0, 0x0, 0x0, 0x0, 0x0, 0x0, 0x0
.long 0x0, 0x0, 0x0, 0x0, 0x0, 0x0, 0x0, 0x0
.long 0x3f80, 0x0, 0x0, 0x0, 0x3f803f80, 0x0, 0x0, 0x0
.long 0x0, 0x3f800000, 0x3f803f80, 0x0, 0x0, 0x0, 0x3f803f80, 0x3f80
.long 0x0, 0x0, 0x3f800000, 0x3f803f80, 0x0, 0x0, 0x0, 0x3f803f80
.long 0x0, 0x0, 0x0, 0x3f800000, 0x0, 0x0, 0x0, 0x0
.long 0x0, 0x0, 0x0, 0x0, 0x0, 0x0, 0x0, 0x0
.long 0x0, 0x0, 0x0, 0x0, 0x0, 0x0, 0x0, 0x0
.long 0x0, 0x0, 0x0, 0x0, 0x0, 0x0, 0x0, 0x0
.long 0x0, 0x0, 0x0, 0x0, 0x0, 0x0, 0x0, 0x0
.long 0x0, 0x0, 0x0, 0x0, 0x0, 0x0, 0x0, 0x0
.long 0x0, 0x0, 0x0, 0x0, 0x0, 0x0, 0x0, 0x0
.long 0x0, 0x0, 0x0, 0x0, 0x3f80, 0x0, 0x0, 0x0
.long 0x3f803f80, 0x0, 0x0, 0x0, 0x3f803f80, 0x3f80, 0x0, 0x0
.long 0x3f800000, 0x3f803f80, 0x0, 0x0, 0x0, 0x3f803f80, 0x3f80, 0x0
.long 0x0, 0x3f800000, 0x3f803f80, 0x0, 0x0, 0x0, 0x3f803f80, 0x3f80
.long 0x0, 0x0, 0x3f800000, 0x3f803f80, 0x0, 0x0, 0x0, 0x3f803f80
.long 0x0, 0x0, 0x0, 0x3f800000, 0x0, 0x0, 0x0, 0x0
.long 0x0, 0x0, 0x0, 0x0, 0x0, 0x0, 0x0, 0x0
.long 0x0, 0x0, 0x0, 0x0, 0x0, 0x0, 0x0, 0x0
.long 0x0, 0x0, 0x0, 0x0, 0x0, 0x0, 0x0, 0x0
.long 0x0, 0x0, 0x0, 0x0, 0x0, 0x0, 0x0, 0x0
.long 0x0, 0x0, 0x0, 0x0, 0x0, 0x0, 0x0, 0x0
.long 0x0, 0x0, 0x0, 0x0, 0x0, 0x0, 0x0, 0x0
.long 0x0, 0x0, 0x0, 0x0, 0x3f80, 0x0, 0x0, 0x0
.long 0x3f803f80, 0x0, 0x0, 0x0, 0x3f803f80, 0x3f80, 0x0, 0x0
.long 0x3f800000, 0x3f803f80, 0x0, 0x0, 0x0, 0x3f803f80, 0x3f80, 0x0
.long 0x0, 0x0, 0x0, 0x0, 0x0, 0x0, 0x0, 0x0
.long 0x0, 0x0, 0x0, 0x0, 0x0, 0x0, 0x0, 0x0
.long 0x0, 0x0, 0x0, 0x0, 0x0, 0x0, 0x0, 0x0
.long 0x0, 0x0, 0x0, 0x0, 0x0, 0x0, 0x0, 0x0
.long 0x0, 0x0, 0x0, 0x0, 0x0, 0x0, 0x0, 0x0
.long 0x0, 0x0, 0x0, 0x0, 0x0, 0x0, 0x0, 0x0
.long 0x0, 0x0, 0x0, 0x0, 0x0, 0x0, 0x0, 0x0
.long 0x0, 0x0, 0x0, 0x0, 0x0, 0x0, 0x0, 0x0
.long 0x0, 0x0, 0x0, 0x3f803f80, 0x0, 0x0, 0x0, 0x3f800000
.long 0x0, 0x0, 0x0, 0x0, 0x0, 0x0, 0x0, 0x0
.long 0x0, 0x0, 0x0, 0x0, 0x0, 0x0, 0x0, 0x0
.long 0x0, 0x0, 0x0, 0x0, 0x0, 0x0, 0x0, 0x0
.long 0x0, 0x0, 0x0, 0x0, 0x0, 0x0, 0x0, 0x0
.long 0x0, 0x0, 0x0, 0x0, 0x0, 0x0, 0x0, 0x0
.long 0x0, 0x0, 0x0, 0x0, 0x0, 0x0, 0x0, 0x0
.long 0x0, 0x0, 0x0, 0x0, 0x0, 0x0, 0x0, 0x0
.long 0x3f803f80, 0x3f80, 0x0, 0x0, 0x3f803f80, 0x3f803f80, 0x0, 0x0
.long 0x3f803f80, 0x3f803f80, 0x3f80, 0x0, 0x3f800000, 0x3f803f80, 0x3f803f80, 0x0
.long 0x0, 0x3f803f80, 0x3f803f80, 0x3f80, 0x0, 0x3f800000, 0x3f803f80, 0x3f803f80
.long 0x0, 0x0, 0x3f803f80, 0x3f803f80, 0x0, 0x0, 0x3f800000, 0x3f803f80
.long 0x0, 0x0, 0x0, 0x3f803f80, 0x0, 0x0, 0x0, 0x3f800000
.long 0x0, 0x0, 0x0, 0x0, 0x0, 0x0, 0x0, 0x0
.long 0x0, 0x0, 0x0, 0x0, 0x0, 0x0, 0x0, 0x0
.long 0x0, 0x0, 0x0, 0x0, 0x0, 0x0, 0x0, 0x0
.long 0x0, 0x0, 0x0, 0x0, 0x0, 0x0, 0x0, 0x0
.long 0x0, 0x0, 0x0, 0x0, 0x0, 0x0, 0x0, 0x0
.long 0x0, 0x0, 0x0, 0x0, 0x0, 0x0, 0x0, 0x0
.long 0x3f80, 0x0, 0x0, 0x0, 0x3f803f80, 0x0, 0x0, 0x0
.long 0x3f803f80, 0x3f80, 0x0, 0x0, 0x3f803f80, 0x3f803f80, 0x0, 0x0
.long 0x3f803f80, 0x3f803f80, 0x3f80, 0x0, 0x3f800000, 0x3f803f80, 0x3f803f80, 0x0
.long 0x0, 0x3f803f80, 0x3f803f80, 0x3f80, 0x0, 0x3f800000, 0x3f803f80, 0x3f803f80
.long 0x0, 0x0, 0x3f803f80, 0x3f803f80, 0x0, 0x0, 0x3f800000, 0x3f803f80
.long 0x0, 0x0, 0x0, 0x0, 0x0, 0x0, 0x0, 0x0
.long 0x0, 0x0, 0x0, 0x0, 0x0, 0x0, 0x0, 0x0
.long 0x0, 0x0, 0x0, 0x0, 0x0, 0x0, 0x0, 0x0
.long 0x0, 0x0, 0x0, 0x0, 0x0, 0x0, 0x0, 0x0
.long 0x0, 0x0, 0x0, 0x0, 0x0, 0x0, 0x0, 0x0
.long 0x0, 0x0, 0x0, 0x0, 0x0, 0x0, 0x0, 0x0
.long 0x0, 0x0, 0x0, 0x0, 0x0, 0x0, 0x0, 0x0
.long 0x3f80, 0x0, 0x0, 0x0, 0x3f803f80, 0x0, 0x0, 0x0
.long 0x0, 0x0, 0x3f800000, 0x3f803f80, 0x0, 0x0, 0x0, 0x3f803f80
.long 0x0, 0x0, 0x0, 0x3f800000, 0x0, 0x0, 0x0, 0x0
.long 0x0, 0x0, 0x0, 0x0, 0x0, 0x0, 0x0, 0x0
.long 0x0, 0x0, 0x0, 0x0, 0x0, 0x0, 0x0, 0x0
.long 0x0, 0x0, 0x0, 0x0, 0x0, 0x0, 0x0, 0x0
.long 0x0, 0x0, 0x0, 0x0, 0x0, 0x0, 0x0, 0x0
.long 0x0, 0x0, 0x0, 0x0, 0x0, 0x0, 0x0, 0x0
.long 0x0, 0x0, 0x0, 0x0, 0x0, 0x0, 0x0, 0x0
.long 0x3f803f80, 0x3f803f80, 0x0, 0x0, 0x3f803f80, 0x3f803f80, 0x3f80, 0x0
.long 0x3f803f80, 0x3f803f80, 0x3f803f80, 0x0, 0x3f803f80, 0x3f803f80, 0x3f803f80, 0x3f80
.long 0x3f800000, 0x3f803f80, 0x3f803f80, 0x3f803f80, 0x0, 0x3f803f80, 0x3f803f80, 0x3f803f80
.long 0x0, 0x3f800000, 0x3f803f80, 0x3f803f80, 0x0, 0x0, 0x3f803f80, 0x3f803f80
.long 0x0, 0x0, 0x3f800000, 0x3f803f80, 0x0, 0x0, 0x0, 0x3f803f80
.long 0x0, 0x0, 0x0, 0x3f800000, 0x0, 0x0, 0x0, 0x0
.long 0x0, 0x0, 0x0, 0x0, 0x0, 0x0, 0x0, 0x0
.long 0x0, 0x0, 0x0, 0x0, 0x0, 0x0, 0x0, 0x0
.long 0x0, 0x0, 0x0, 0x0, 0x0, 0x0, 0x0, 0x0
.long 0x0, 0x0, 0x0, 0x0, 0x0, 0x0, 0x0, 0x0
.long 0x0, 0x0, 0x0, 0x0, 0x3f80, 0x0, 0x0, 0x0
.long 0x3f803f80, 0x0, 0x0, 0x0, 0x3f803f80, 0x3f80, 0x0, 0x0
.long 0x3f803f80, 0x3f803f80, 0x0, 0x0, 0x3f803f80, 0x3f803f80, 0x3f80, 0x0
.long 0x3f803f80, 0x3f803f80, 0x3f803f80, 0x0, 0x3f803f80, 0x3f803f80, 0x3f803f80, 0x3f80
.long 0x3f800000, 0x3f803f80, 0x3f803f80, 0x3f803f80, 0x0, 0x3f803f80, 0x3f803f80, 0x3f803f80
.long 0x0, 0x3f800000, 0x3f803f80, 0x3f803f80, 0x0, 0x0, 0x3f803f80, 0x3f803f80
.long 0x0, 0x0, 0x0, 0x0, 0x0, 0x0, 0x0, 0x0
.long 0x0, 0x0, 0x0, 0x0, 0x0, 0x0, 0x0, 0x0
.long 0x0, 0x0, 0x0, 0x0, 0x0, 0x0, 0x0, 0x0
.long 0x0, 0x0, 0x0, 0x0, 0x0, 0x0, 0x0, 0x0
.long 0x0, 0x0, 0x0, 0x0, 0x0, 0x0, 0x0, 0x0
.long 0x0, 0x0, 0x0, 0x0, 0x0, 0x0, 0x0, 0x0
.long 0x0, 0x0, 0x0, 0x0, 0x3f80, 0x0, 0x0, 0x0
.long 0x3f803f80, 0x0, 0x0, 0x0, 0x3f803f80, 0x3f80, 0x0, 0x0
.long 0x0, 0x0, 0x3f803f80, 0x3f803f80, 0x0, 0x0, 0x3f800000, 0x3f803f80
.long 0x0, 0x0, 0x0, 0x3f803f80, 0x0, 0x0, 0x0, 0x3f800000
.long 0x0, 0x0, 0x0, 0x0, 0x0, 0x0, 0x0, 0x0
.long 0x0, 0x0, 0x0, 0x0, 0x0, 0x0, 0x0, 0x0
.long 0x0, 0x0, 0x0, 0x0, 0x0, 0x0, 0x0, 0x0
.long 0x0, 0x0, 0x0, 0x0, 0x0, 0x0, 0x0, 0x0
.long 0x0, 0x0, 0x0, 0x0, 0x0, 0x0, 0x0, 0x0
.long 0x0, 0x0, 0x0, 0x0, 0x0, 0x0, 0x0, 0x0
.long 0x3f803f80, 0x3f803f80, 0x3f80, 0x0, 0x3f803f80, 0x3f803f80, 0x3f803f80, 0x0
.long 0x3f803f80, 0x3f803f80, 0x3f803f80, 0x3f80, 0x3f803f80, 0x3f803f80, 0x3f803f80, 0x3f803f80
.long 0x3f803f80, 0x3f803f80, 0x3f803f80, 0x3f803f80, 0x3f800000, 0x3f803f80, 0x3f803f80, 0x3f803f80
.long 0x0, 0x3f803f80, 0x3f803f80, 0x3f803f80, 0x0, 0x3f800000, 0x3f803f80, 0x3f803f80
.long 0x0, 0x0, 0x3f803f80, 0x3f803f80, 0x0, 0x0, 0x3f800000, 0x3f803f80
.long 0x0, 0x0, 0x0, 0x3f803f80, 0x0, 0x0, 0x0, 0x3f800000
.long 0x0, 0x0, 0x0, 0x0, 0x0, 0x0, 0x0, 0x0
.long 0x0, 0x0, 0x0, 0x0, 0x0, 0x0, 0x0, 0x0
.long 0x0, 0x0, 0x0, 0x0, 0x0, 0x0, 0x0, 0x0
.long 0x0, 0x0, 0x0, 0x0, 0x0, 0x0, 0x0, 0x0
.long 0x3f80, 0x0, 0x0, 0x0, 0x3f803f80, 0x0, 0x0, 0x0
.long 0x3f803f80, 0x3f80, 0x0, 0x0, 0x3f803f80, 0x3f803f80, 0x0, 0x0
.long 0x3f803f80, 0x3f803f80, 0x3f80, 0x0, 0x3f803f80, 0x3f803f80, 0x3f803f80, 0x0
.long 0x3f803f80, 0x3f803f80, 0x3f803f80, 0x3f80, 0x3f803f80, 0x3f803f80, 0x3f803f80, 0x3f803f80
.long 0x3f803f80, 0x3f803f80, 0x3f803f80, 0x3f803f80, 0x3f800000, 0x3f803f80, 0x3f803f80, 0x3f803f80
.long 0x0, 0x3f803f80, 0x3f803f80, 0x3f803f80, 0x0, 0x3f800000, 0x3f803f80, 0x3f803f80
.long 0x0, 0x0, 0x0, 0x0, 0x0, 0x0, 0x0, 0x0
.long 0x0, 0x0, 0x0, 0x0, 0x0, 0x0, 0x0, 0x0
.long 0x0, 0x0, 0x0, 0x0, 0x0, 0x0, 0x0, 0x0
.long 0x0, 0x0, 0x0, 0x0, 0x0, 0x0, 0x0, 0x0
.long 0x0, 0x0, 0x0, 0x0, 0x0, 0x0, 0x0, 0x0
.long 0x0, 0x0, 0x0, 0x0, 0x0, 0x0, 0x0, 0x0
.long 0x3f80, 0x0, 0x0, 0x0, 0x3f803f80, 0x0, 0x0, 0x0
.long 0x3f803f80, 0x3f80, 0x0, 0x0, 0x3f803f80, 0x3f803f80, 0x0, 0x0
.size K1_TABLE, 9216
CODE_END:
.section .rodata,"a"
.p2align 6
.amdhsa_kernel gated_mix__linear_attn_block__ssm_conv_s4__prompt_kernel
  .amdhsa_next_free_vgpr 256
  .amdhsa_next_free_sgpr 102
  .amdhsa_accum_offset 256
  .amdhsa_group_segment_fixed_size 0
  .amdhsa_kernarg_size 128
  .amdhsa_user_sgpr_count 2
  .amdhsa_user_sgpr_kernarg_segment_ptr 1
  .amdhsa_system_sgpr_workgroup_id_x 1
.end_amdhsa_kernel
```
